```python
import torch

def _softmax(x, axis=-1):
    return torch.softmax(x, dim=axis)
def _gelu(x):
    return torch.nn.functional.gelu(x, approximate="tanh")
def _silu(x):
    return torch.nn.functional.silu(x)
def _sigmoid(x):
    return torch.sigmoid(x)
def _layernorm(x, axis=-1, eps=1e-5):
    m = x.mean(dim=axis, keepdim=True)
    v = x.var(dim=axis, keepdim=True, unbiased=False)
    return (x - m) / torch.sqrt(v + eps)
def _scatter_add(tgt, idx, src, axis=0):
    return tgt.clone().index_add_(axis, idx, src)
def _segment_sum(src, seg, n):
    out = torch.zeros((n,) + src.shape[1:], dtype=src.dtype)
    return out.index_add_(0, seg, src)
def _pad(x, pw):
    flat = tuple(v for pair in reversed(pw) for v in pair)
    return torch.nn.functional.pad(x, flat)

kernel_name = 'standalone__molecular_angular_gemnet__graph'

def setup_inputs():

    _w = (lambda a: (lambda t: t.to(torch.bfloat16) if t.is_floating_point() else t)(torch.as_tensor(a)))
    N, deg, De, L = 50000, 16, 4, 1
    E = N * deg
    T = E * deg
    NR = 8
    dist = torch.rand(E).to(float)
    angle = (torch.rand(T) * torch.pi).to(float)
    centers = torch.linspace(0.0, 1.0, NR).to(float)
    ang_freq = torch.arange(1, L + 1).to(float)
    return {
        "m": _w((lambda *s: torch.randn(*s, dtype=torch.bfloat16) * 0.05)(E, De)),
        "idx_in": _w((lambda lo, hi, *s: torch.randint(lo, hi, s))(0, E, T).to(torch.int64)),
        "idx_out": _w((lambda lo, hi, *s: torch.randint(lo, hi, s))(0, E, T).to(torch.int64)),
        "dist": _w(dist),
        "angle": _w(angle),
        "centers": _w(centers),
        "ang_freq": _w(ang_freq),
        "w_rbf": _w((lambda *s: torch.randn(*s, dtype=torch.bfloat16) * 0.4)(NR, De)),
        "w_sbf": _w((lambda *s: torch.randn(*s, dtype=torch.bfloat16) * 0.4)(NR * L, De)),
        "w_down": _w((lambda *s: torch.randn(*s, dtype=torch.bfloat16) * 0.4)(De, De)),
        "w_up": _w((lambda *s: torch.randn(*s, dtype=torch.bfloat16) * 0.4)(De, De)),
    }

def reference(m, idx_in, idx_out, dist, angle, centers, ang_freq, w_rbf, w_sbf, w_down, w_up):
    E, De = m.shape[0], m.shape[1]
    NR = centers.shape[0]
    L = ang_freq.shape[0]
    rbf = torch.exp(-10.0 * (dist[:, None] - centers[None, :]) ** 2)
    cbf = torch.cos(ang_freq[None, :] * angle[:, None])
    rbf_t = rbf[idx_out]
    sbf = torch.reshape(rbf_t[:, :, None] * cbf[:, None, :], (-1, NR * L))
    x = (m[idx_in] @ w_down) * (sbf @ w_sbf)
    agg = _segment_sum(x, idx_out, E)
    return m + (agg @ w_up) * (rbf @ w_rbf)
```

```asm
; @launch kernel=p1_kernel grid=(256,1,1) block=(1024,1,1) lds=157728
; @launch kernel=p2_kernel grid=(256,1,1) block=(1024,1,1) lds=163840
.amdgcn_target "amdgcn-amd-amdhsa--gfx950"
.text
.globl p1_kernel
.p2align 8
.type p1_kernel,@function
p1_kernel:
    s_cmp_ge_u32 s2, 256
    s_cbranch_scc1 L_p1_kernel_end
    s_load_dwordx4 s[4:7], s[0:1], 8
    s_load_dwordx2 s[40:41], s[0:1], 32
    s_load_dwordx2 s[42:43], s[0:1], 48
    s_load_dwordx2 s[36:37], s[0:1], 104
    v_lshlrev_b32 v1, 4, v0
    v_lshlrev_b32 v2, 3, v0
    v_lshrrev_b32 v5, 6, v0
    s_mul_i32 s3, s2, 6144
    v_readfirstlane_b32 s38, v5
    s_mul_i32 s38, s38, 1571840
    s_add_u32 s3, s3, s38
    s_sub_u32 s94, 51200000, s3
    s_mul_i32 s86, s2, 13
    s_min_u32 s38, s2, 64
    s_add_u32 s86, s86, s38
    s_lshl_b32 s86, s86, 8
    s_add_u32 s86, s86, 50331648
    s_sub_u32 s86, s86, s3
    s_waitcnt lgkmcnt(0)
    s_add_u32 s8, s4, s3
    s_addc_u32 s9, s5, 0
    s_mov_b32 s10, s94
    s_mov_b32 s11, 0x00020000
    s_add_u32 s12, s6, s3
    s_addc_u32 s13, s7, 0
    s_mov_b32 s14, s94
    s_mov_b32 s15, 0x00020000
    s_lshr_b32 s3, s3, 1
    s_add_u32 s16, s40, s3
    s_addc_u32 s17, s41, 0
    s_lshr_b32 s18, s94, 1
    s_mov_b32 s19, 0x00020000
    s_getpc_b64 s[20:21]
    s_lshr_b32 s3, s2, 3
    s_mul_i32 s3, s3, 11
    v_add_lshl_u32 v16, v0, s3, 7
    s_mov_b32 s22, L_code_end - p1_kernel - 256
    s_mov_b32 s23, 0x00020000
    v_cmp_gt_u32 vcc, 11, v0
    s_mov_b64 exec, vcc
    buffer_load_dword v16, v16, s[20:23], 0 offen
    s_mov_b64 exec, -1
    v_mov_b32 v19, 0
    global_load_ushort v19, v19, s[42:43]
    s_mov_b32 s38, 0
    buffer_load_dwordx4 v[56:59], v1, s[12:15], s38 offen nt
    buffer_load_dwordx4 v[32:35], v1, s[8:11], s38 offen nt
    s_mov_b32 s38, 0
    buffer_load_dwordx2 v[20:21], v2, s[16:19], s38 offen nt
    s_mov_b32 s38, 1024
    buffer_load_dwordx4 v[60:63], v1, s[12:15], s38 offen nt
    buffer_load_dwordx4 v[36:39], v1, s[8:11], s38 offen nt
    s_mov_b32 s38, 512
    buffer_load_dwordx2 v[22:23], v2, s[16:19], s38 offen nt
    s_mov_b32 s38, 2048
    buffer_load_dwordx4 v[64:67], v1, s[12:15], s38 offen nt
    buffer_load_dwordx4 v[40:43], v1, s[8:11], s38 offen nt
    s_mov_b32 s38, 1024
    buffer_load_dwordx2 v[24:25], v2, s[16:19], s38 offen nt
    s_load_dwordx2 s[64:65], s[0:1], 0
    s_load_dwordx2 s[68:69], s[0:1], 24
    s_mov_b32 s66, 6400000
    s_mov_b32 s67, 0x00020000
    s_mov_b32 s70, 1600000
    s_mov_b32 s71, 0x00020000
    s_add_u32 s84, s36, 87032832
    s_addc_u32 s85, s37, 0
    s_waitcnt lgkmcnt(0)
    s_mul_i32 s3, s2, 25088
    v_add_u32 v18, s3, v1
    v_mov_b32 v84, 0
    v_mov_b32 v85, 0
    v_mov_b32 v86, 0
    v_mov_b32 v87, 0
    v_cmp_gt_u32 vcc, 544, v0
    buffer_load_dwordx4 v[80:83], v18, s[64:67], 0 offen
    v_add_u32 v18, 16384, v18
    s_mov_b64 exec, vcc
    buffer_load_dwordx4 v[84:87], v18, s[64:67], 0 offen
    s_mov_b64 exec, -1
    s_mul_i32 s3, s2, 49
    v_add_lshl_u32 v15, v0, s3, 7
    v_cmp_gt_u32 vcc, 49, v0
    s_mov_b64 exec, vcc
    buffer_load_dword v15, v15, s[68:71], 0 offen
    s_mov_b64 exec, -1
    s_mul_i32 s3, s2, 303360
    s_add_u32 s20, s36, s3
    s_addc_u32 s21, s37, 0
    s_mov_b32 s22, 147456
    s_mov_b32 s23, 0x00020000
    s_add_u32 s24, s20, 151680
    s_addc_u32 s25, s21, 0
    s_mov_b32 s26, 147456
    s_mov_b32 s27, 0x00020000
    s_mul_i32 s3, s2, 10240
    s_add_u32 s3, s3, 83886080
    s_add_u32 s28, s36, s3
    s_addc_u32 s29, s37, 0
    s_mov_b32 s30, 10240
    s_mov_b32 s31, 0x00020000
    s_mov_b32 s32, 343268
    s_mov_b32 s33, 4294954784
    s_mov_b32 s34, 1717987
    s_mov_b32 s35, 4294927296
    s_mov_b32 s37, 0x0fffffff
    v_mov_b32 v17, 0x40000
    s_mov_b32 s96, 4294967200
    s_mov_b32 s87, 36864
    s_mov_b32 s97, 0x04000400
    s_mov_b32 s95, 0xffe00000
    v_mov_b32 v3, 1
    v_mov_b32 v4, 21846
    v_lshrrev_b32 v5, 6, v0
    v_mov_b32 v6, 0
    v_mov_b32 v7, 0
    v_mov_b32 v8, 0
    v_mov_b32 v9, 0
    v_readfirstlane_b32 s39, v5
    s_waitcnt lgkmcnt(0)
    v_cmp_gt_u32 vcc, 642, v0
    s_and_saveexec_b64 s[40:41], vcc
    ds_write_b128 v1, v[6:9]
    s_mov_b64 exec, -1
    s_movk_i32 s38, 448
    v_cmp_gt_u32 s[40:41], s38, v0
    s_cmp_lt_u32 s2, 64
    s_cselect_b32 s38, 64, 0
    s_add_u32 s38, s38, 384
    v_cmp_gt_u32 s[92:93], s38, v0
    s_waitcnt lgkmcnt(0)
    s_barrier
    s_or_b32 s38, s2, s39
    s_cbranch_scc1 L_p1_kernel_w0
    s_load_dwordx8 s[72:79], s[0:1], 56
    s_load_dwordx2 s[80:81], s[0:1], 40
    v_lshlrev_b32 v92, 1, v0
    s_mov_b32 exec_hi, 0
    s_waitcnt lgkmcnt(0)
    global_load_ushort v88, v92, s[72:73]
    global_load_ushort v89, v92, s[74:75]
    s_mov_b32 exec_lo, 0xffff
    global_load_ushort v90, v92, s[76:77]
    global_load_ushort v91, v92, s[78:79]
    s_mov_b32 exec_lo, 0xff
    global_load_ushort v93, v92, s[80:81]
    s_mov_b64 exec, -1
L_p1_kernel_w0:
    s_mov_b32 s38, 3072
    buffer_load_dwordx4 v[68:71], v1, s[12:15], s38 offen nt
    buffer_load_dwordx4 v[44:47], v1, s[8:11], s38 offen nt
    s_mov_b32 s38, 1536
    buffer_load_dwordx2 v[26:27], v2, s[16:19], s38 offen nt
    s_waitcnt vmcnt(14)
    v_mul_hi_u32_u24 v5, s32, v56
    v_mul_hi_u32_u24 v6, s32, v57
    v_mul_hi_u32_u24 v7, s32, v58
    v_mul_hi_u32_u24 v8, s32, v59
    v_mad_i32_i24 v56, v5, s33, v56
    v_mad_i32_i24 v57, v6, s33, v57
    v_mad_i32_i24 v58, v7, s33, v58
    v_mad_i32_i24 v59, v8, s33, v59
    s_waitcnt vmcnt(13)
    v_lshrrev_b32 v9, 4, v32
    v_lshrrev_b32 v10, 4, v33
    v_lshrrev_b32 v11, 4, v34
    v_lshrrev_b32 v12, 4, v35
    v_mul_hi_u32_u24 v9, s34, v9
    v_mul_hi_u32_u24 v10, s34, v10
    v_mul_hi_u32_u24 v11, s34, v11
    v_mul_hi_u32_u24 v12, s34, v12
    v_mad_i32_i24 v32, v9, s35, v32
    v_lshl_add_u32 v5, v9, 6, v5
    v_mad_i32_i24 v33, v10, s35, v33
    v_lshl_add_u32 v6, v10, 6, v6
    v_mad_i32_i24 v34, v11, s35, v34
    v_lshl_add_u32 v7, v11, 6, v7
    v_mad_i32_i24 v35, v12, s35, v35
    v_lshl_add_u32 v8, v12, 6, v8
    v_mul_u32_u24 v9, 43691, v32
    v_lshl_add_u32 v32, v56, 7, v32
    v_lshlrev_b32 v5, 2, v5
    v_mul_u32_u24 v10, 43691, v33
    v_lshl_add_u32 v33, v57, 7, v33
    v_lshlrev_b32 v6, 2, v6
    v_mul_u32_u24 v11, 43691, v34
    v_lshl_add_u32 v34, v58, 7, v34
    v_lshlrev_b32 v7, 2, v7
    v_mul_u32_u24 v12, 43691, v35
    v_lshl_add_u32 v35, v59, 7, v35
    v_lshlrev_b32 v8, 2, v8
    ds_add_u32 v5, v3 offset:0
    ds_add_u32 v6, v3 offset:0
    ds_add_u32 v7, v3 offset:0
    ds_add_u32 v8, v3 offset:0
    v_lshrrev_b32 v9, 22, v9
    v_lshl_or_b32 v56, v5, 25, v5
    v_lshrrev_b32 v10, 22, v10
    v_lshl_or_b32 v57, v6, 25, v6
    v_lshrrev_b32 v11, 22, v11
    v_lshl_or_b32 v58, v7, 25, v7
    v_lshrrev_b32 v12, 22, v12
    v_lshl_or_b32 v59, v8, 25, v8
    v_and_or_b32 v56, v56, s37, v17
    v_and_or_b32 v57, v57, s37, v17
    v_and_or_b32 v58, v58, s37, v17
    v_and_or_b32 v59, v59, s37, v17
    v_mad_i32_i24 v32, v9, s96, v32
    v_lshl_add_u32 v56, v9, 18, v56
    v_mad_i32_i24 v33, v10, s96, v33
    v_lshl_add_u32 v57, v10, 18, v57
    v_mad_i32_i24 v34, v11, s96, v34
    v_lshl_add_u32 v58, v11, 18, v58
    v_mad_i32_i24 v35, v12, s96, v35
    v_lshl_add_u32 v59, v12, 18, v59
    v_readfirstlane_b32 s36, v19
    s_lshl_b32 s36, s36, 16
    s_waitcnt vmcnt(12)
    s_cmp_eq_u32 s36, 1.0
    s_cbranch_scc1 L_p1_kernel_f0_0
    v_lshlrev_b32 v5, 16, v20
    v_and_b32 v6, 0xffff0000, v20
    v_lshlrev_b32 v7, 16, v21
    v_and_b32 v8, 0xffff0000, v21
    v_mul_f32 v5, s36, v5
    v_mul_f32 v6, s36, v6
    v_mul_f32 v7, s36, v7
    v_mul_f32 v8, s36, v8
    v_cvt_pk_bf16_f32 v20, v5, v6
    v_cvt_pk_bf16_f32 v21, v7, v8
L_p1_kernel_f0_0:
    v_lshlrev_b32 v5, 16, v20
    v_and_b32 v6, 0xffff0000, v20
    v_lshlrev_b32 v7, 16, v21
    v_and_b32 v8, 0xffff0000, v21
    v_mul_f32 v5, 0.15915494, v5
    v_mul_f32 v6, 0.15915494, v6
    v_mul_f32 v7, 0.15915494, v7
    v_mul_f32 v8, 0.15915494, v8
    v_fract_f32 v5, v5
    v_fract_f32 v6, v6
    v_fract_f32 v7, v7
    v_fract_f32 v8, v8
    v_cos_f32 v5, v5
    v_cos_f32 v6, v6
    v_cos_f32 v7, v7
    v_cos_f32 v8, v8
    v_mul_f32 v5, 0x03800000, v5
    v_mul_f32 v6, 0x03800000, v6
    v_mul_f32 v7, 0x03800000, v7
    v_mul_f32 v8, 0x03800000, v8
    v_cvt_pk_bf16_f32 v9, v5, v6
    v_cvt_pk_bf16_f32 v10, v7, v8
    v_lshrrev_b32 v5, 5, v9
    v_lshrrev_b32 v6, 5, v10
    v_bfi_b32 v9, s97, v5, v9
    v_bfi_b32 v10, s97, v6, v10
    v_lshl_or_b32 v32, v9, 21, v32
    v_lshlrev_b32 v5, 5, v9
    v_lshl_or_b32 v34, v10, 21, v34
    v_lshlrev_b32 v6, 5, v10
    v_and_or_b32 v33, v5, s95, v33
    v_and_or_b32 v35, v6, s95, v35
    s_waitcnt vmcnt(11)
    v_mul_hi_u32_u24 v5, s32, v60
    v_mul_hi_u32_u24 v6, s32, v61
    v_mul_hi_u32_u24 v7, s32, v62
    v_mul_hi_u32_u24 v8, s32, v63
    v_mad_i32_i24 v60, v5, s33, v60
    v_mad_i32_i24 v61, v6, s33, v61
    v_mad_i32_i24 v62, v7, s33, v62
    v_mad_i32_i24 v63, v8, s33, v63
    s_waitcnt vmcnt(10)
    v_lshrrev_b32 v9, 4, v36
    v_lshrrev_b32 v10, 4, v37
    v_lshrrev_b32 v11, 4, v38
    v_lshrrev_b32 v12, 4, v39
    v_mul_hi_u32_u24 v9, s34, v9
    v_mul_hi_u32_u24 v10, s34, v10
    v_mul_hi_u32_u24 v11, s34, v11
    v_mul_hi_u32_u24 v12, s34, v12
    v_mad_i32_i24 v36, v9, s35, v36
    v_lshl_add_u32 v5, v9, 6, v5
    v_mad_i32_i24 v37, v10, s35, v37
    v_lshl_add_u32 v6, v10, 6, v6
    v_mad_i32_i24 v38, v11, s35, v38
    v_lshl_add_u32 v7, v11, 6, v7
    v_mad_i32_i24 v39, v12, s35, v39
    v_lshl_add_u32 v8, v12, 6, v8
    v_mul_u32_u24 v9, 43691, v36
    v_lshl_add_u32 v36, v60, 7, v36
    v_lshlrev_b32 v5, 2, v5
    v_mul_u32_u24 v10, 43691, v37
    v_lshl_add_u32 v37, v61, 7, v37
    v_lshlrev_b32 v6, 2, v6
    v_mul_u32_u24 v11, 43691, v38
    v_lshl_add_u32 v38, v62, 7, v38
    v_lshlrev_b32 v7, 2, v7
    v_mul_u32_u24 v12, 43691, v39
    v_lshl_add_u32 v39, v63, 7, v39
    v_lshlrev_b32 v8, 2, v8
    ds_add_u32 v5, v3 offset:0
    ds_add_u32 v6, v3 offset:0
    ds_add_u32 v7, v3 offset:0
    ds_add_u32 v8, v3 offset:0
    v_lshrrev_b32 v9, 22, v9
    v_lshl_or_b32 v60, v5, 25, v5
    v_lshrrev_b32 v10, 22, v10
    v_lshl_or_b32 v61, v6, 25, v6
    v_lshrrev_b32 v11, 22, v11
    v_lshl_or_b32 v62, v7, 25, v7
    v_lshrrev_b32 v12, 22, v12
    v_lshl_or_b32 v63, v8, 25, v8
    v_and_or_b32 v60, v60, s37, v17
    v_and_or_b32 v61, v61, s37, v17
    v_and_or_b32 v62, v62, s37, v17
    v_and_or_b32 v63, v63, s37, v17
    v_mad_i32_i24 v36, v9, s96, v36
    v_lshl_add_u32 v60, v9, 18, v60
    v_mad_i32_i24 v37, v10, s96, v37
    v_lshl_add_u32 v61, v10, 18, v61
    v_mad_i32_i24 v38, v11, s96, v38
    v_lshl_add_u32 v62, v11, 18, v62
    v_mad_i32_i24 v39, v12, s96, v39
    v_lshl_add_u32 v63, v12, 18, v63
    s_waitcnt vmcnt(9)
    s_cmp_eq_u32 s36, 1.0
    s_cbranch_scc1 L_p1_kernel_f0_1
    v_lshlrev_b32 v5, 16, v22
    v_and_b32 v6, 0xffff0000, v22
    v_lshlrev_b32 v7, 16, v23
    v_and_b32 v8, 0xffff0000, v23
    v_mul_f32 v5, s36, v5
    v_mul_f32 v6, s36, v6
    v_mul_f32 v7, s36, v7
    v_mul_f32 v8, s36, v8
    v_cvt_pk_bf16_f32 v22, v5, v6
    v_cvt_pk_bf16_f32 v23, v7, v8
L_p1_kernel_f0_1:
    v_lshlrev_b32 v5, 16, v22
    v_and_b32 v6, 0xffff0000, v22
    v_lshlrev_b32 v7, 16, v23
    v_and_b32 v8, 0xffff0000, v23
    v_mul_f32 v5, 0.15915494, v5
    v_mul_f32 v6, 0.15915494, v6
    v_mul_f32 v7, 0.15915494, v7
    v_mul_f32 v8, 0.15915494, v8
    v_fract_f32 v5, v5
    v_fract_f32 v6, v6
    v_fract_f32 v7, v7
    v_fract_f32 v8, v8
    v_cos_f32 v5, v5
    v_cos_f32 v6, v6
    v_cos_f32 v7, v7
    v_cos_f32 v8, v8
    v_mul_f32 v5, 0x03800000, v5
    v_mul_f32 v6, 0x03800000, v6
    v_mul_f32 v7, 0x03800000, v7
    v_mul_f32 v8, 0x03800000, v8
    v_cvt_pk_bf16_f32 v9, v5, v6
    v_cvt_pk_bf16_f32 v10, v7, v8
    v_lshrrev_b32 v5, 5, v9
    v_lshrrev_b32 v6, 5, v10
    v_bfi_b32 v9, s97, v5, v9
    v_bfi_b32 v10, s97, v6, v10
    v_lshl_or_b32 v36, v9, 21, v36
    v_lshlrev_b32 v5, 5, v9
    v_lshl_or_b32 v38, v10, 21, v38
    v_lshlrev_b32 v6, 5, v10
    v_and_or_b32 v37, v5, s95, v37
    v_and_or_b32 v39, v6, s95, v39
    s_mov_b32 s38, 4096
    buffer_load_dwordx4 v[72:75], v1, s[12:15], s38 offen nt
    buffer_load_dwordx4 v[48:51], v1, s[8:11], s38 offen nt
    s_mov_b32 s38, 2048
    buffer_load_dwordx2 v[20:21], v2, s[16:19], s38 offen nt
    s_waitcnt vmcnt(11)
    v_mul_hi_u32_u24 v5, s32, v64
    v_mul_hi_u32_u24 v6, s32, v65
    v_mul_hi_u32_u24 v7, s32, v66
    v_mul_hi_u32_u24 v8, s32, v67
    v_mad_i32_i24 v64, v5, s33, v64
    v_mad_i32_i24 v65, v6, s33, v65
    v_mad_i32_i24 v66, v7, s33, v66
    v_mad_i32_i24 v67, v8, s33, v67
    s_waitcnt vmcnt(10)
    v_lshrrev_b32 v9, 4, v40
    v_lshrrev_b32 v10, 4, v41
    v_lshrrev_b32 v11, 4, v42
    v_lshrrev_b32 v12, 4, v43
    v_mul_hi_u32_u24 v9, s34, v9
    v_mul_hi_u32_u24 v10, s34, v10
    v_mul_hi_u32_u24 v11, s34, v11
    v_mul_hi_u32_u24 v12, s34, v12
    v_mad_i32_i24 v40, v9, s35, v40
    v_lshl_add_u32 v5, v9, 6, v5
    v_mad_i32_i24 v41, v10, s35, v41
    v_lshl_add_u32 v6, v10, 6, v6
    v_mad_i32_i24 v42, v11, s35, v42
    v_lshl_add_u32 v7, v11, 6, v7
    v_mad_i32_i24 v43, v12, s35, v43
    v_lshl_add_u32 v8, v12, 6, v8
    v_mul_u32_u24 v9, 43691, v40
    v_lshl_add_u32 v40, v64, 7, v40
    v_lshlrev_b32 v5, 2, v5
    v_mul_u32_u24 v10, 43691, v41
    v_lshl_add_u32 v41, v65, 7, v41
    v_lshlrev_b32 v6, 2, v6
    v_mul_u32_u24 v11, 43691, v42
    v_lshl_add_u32 v42, v66, 7, v42
    v_lshlrev_b32 v7, 2, v7
    v_mul_u32_u24 v12, 43691, v43
    v_lshl_add_u32 v43, v67, 7, v43
    v_lshlrev_b32 v8, 2, v8
    ds_add_u32 v5, v3 offset:0
    ds_add_u32 v6, v3 offset:0
    ds_add_u32 v7, v3 offset:0
    ds_add_u32 v8, v3 offset:0
    v_lshrrev_b32 v9, 22, v9
    v_lshl_or_b32 v64, v5, 25, v5
    v_lshrrev_b32 v10, 22, v10
    v_lshl_or_b32 v65, v6, 25, v6
    v_lshrrev_b32 v11, 22, v11
    v_lshl_or_b32 v66, v7, 25, v7
    v_lshrrev_b32 v12, 22, v12
    v_lshl_or_b32 v67, v8, 25, v8
    v_and_or_b32 v64, v64, s37, v17
    v_and_or_b32 v65, v65, s37, v17
    v_and_or_b32 v66, v66, s37, v17
    v_and_or_b32 v67, v67, s37, v17
    v_mad_i32_i24 v40, v9, s96, v40
    v_lshl_add_u32 v64, v9, 18, v64
    v_mad_i32_i24 v41, v10, s96, v41
    v_lshl_add_u32 v65, v10, 18, v65
    v_mad_i32_i24 v42, v11, s96, v42
    v_lshl_add_u32 v66, v11, 18, v66
    v_mad_i32_i24 v43, v12, s96, v43
    v_lshl_add_u32 v67, v12, 18, v67
    s_waitcnt vmcnt(9)
    s_cmp_eq_u32 s36, 1.0
    s_cbranch_scc1 L_p1_kernel_f0_2
    v_lshlrev_b32 v5, 16, v24
    v_and_b32 v6, 0xffff0000, v24
    v_lshlrev_b32 v7, 16, v25
    v_and_b32 v8, 0xffff0000, v25
    v_mul_f32 v5, s36, v5
    v_mul_f32 v6, s36, v6
    v_mul_f32 v7, s36, v7
    v_mul_f32 v8, s36, v8
    v_cvt_pk_bf16_f32 v24, v5, v6
    v_cvt_pk_bf16_f32 v25, v7, v8
L_p1_kernel_f0_2:
    v_lshlrev_b32 v5, 16, v24
    v_and_b32 v6, 0xffff0000, v24
    v_lshlrev_b32 v7, 16, v25
    v_and_b32 v8, 0xffff0000, v25
    v_mul_f32 v5, 0.15915494, v5
    v_mul_f32 v6, 0.15915494, v6
    v_mul_f32 v7, 0.15915494, v7
    v_mul_f32 v8, 0.15915494, v8
    v_fract_f32 v5, v5
    v_fract_f32 v6, v6
    v_fract_f32 v7, v7
    v_fract_f32 v8, v8
    v_cos_f32 v5, v5
    v_cos_f32 v6, v6
    v_cos_f32 v7, v7
    v_cos_f32 v8, v8
    v_mul_f32 v5, 0x03800000, v5
    v_mul_f32 v6, 0x03800000, v6
    v_mul_f32 v7, 0x03800000, v7
    v_mul_f32 v8, 0x03800000, v8
    v_cvt_pk_bf16_f32 v9, v5, v6
    v_cvt_pk_bf16_f32 v10, v7, v8
    v_lshrrev_b32 v5, 5, v9
    v_lshrrev_b32 v6, 5, v10
    v_bfi_b32 v9, s97, v5, v9
    v_bfi_b32 v10, s97, v6, v10
    v_lshl_or_b32 v40, v9, 21, v40
    v_lshlrev_b32 v5, 5, v9
    v_lshl_or_b32 v42, v10, 21, v42
    v_lshlrev_b32 v6, 5, v10
    v_and_or_b32 v41, v5, s95, v41
    v_and_or_b32 v43, v6, s95, v43
    s_mov_b32 s38, 5120
    buffer_load_dwordx4 v[76:79], v1, s[12:15], s38 offen nt
    buffer_load_dwordx4 v[52:55], v1, s[8:11], s38 offen nt
    s_mov_b32 s38, 2560
    buffer_load_dwordx2 v[22:23], v2, s[16:19], s38 offen nt
    s_waitcnt vmcnt(8)
    v_mul_hi_u32_u24 v5, s32, v68
    v_mul_hi_u32_u24 v6, s32, v69
    v_mul_hi_u32_u24 v7, s32, v70
    v_mul_hi_u32_u24 v8, s32, v71
    v_mad_i32_i24 v68, v5, s33, v68
    v_mad_i32_i24 v69, v6, s33, v69
    v_mad_i32_i24 v70, v7, s33, v70
    v_mad_i32_i24 v71, v8, s33, v71
    s_waitcnt vmcnt(7)
    v_lshrrev_b32 v9, 4, v44
    v_lshrrev_b32 v10, 4, v45
    v_lshrrev_b32 v11, 4, v46
    v_lshrrev_b32 v12, 4, v47
    v_mul_hi_u32_u24 v9, s34, v9
    v_mul_hi_u32_u24 v10, s34, v10
    v_mul_hi_u32_u24 v11, s34, v11
    v_mul_hi_u32_u24 v12, s34, v12
    v_mad_i32_i24 v44, v9, s35, v44
    v_lshl_add_u32 v5, v9, 6, v5
    v_mad_i32_i24 v45, v10, s35, v45
    v_lshl_add_u32 v6, v10, 6, v6
    v_mad_i32_i24 v46, v11, s35, v46
    v_lshl_add_u32 v7, v11, 6, v7
    v_mad_i32_i24 v47, v12, s35, v47
    v_lshl_add_u32 v8, v12, 6, v8
    v_mul_u32_u24 v9, 43691, v44
    v_lshl_add_u32 v44, v68, 7, v44
    v_lshlrev_b32 v5, 2, v5
    v_mul_u32_u24 v10, 43691, v45
    v_lshl_add_u32 v45, v69, 7, v45
    v_lshlrev_b32 v6, 2, v6
    v_mul_u32_u24 v11, 43691, v46
    v_lshl_add_u32 v46, v70, 7, v46
    v_lshlrev_b32 v7, 2, v7
    v_mul_u32_u24 v12, 43691, v47
    v_lshl_add_u32 v47, v71, 7, v47
    v_lshlrev_b32 v8, 2, v8
    ds_add_u32 v5, v3 offset:0
    ds_add_u32 v6, v3 offset:0
    ds_add_u32 v7, v3 offset:0
    ds_add_u32 v8, v3 offset:0
    v_lshrrev_b32 v9, 22, v9
    v_lshl_or_b32 v68, v5, 25, v5
    v_lshrrev_b32 v10, 22, v10
    v_lshl_or_b32 v69, v6, 25, v6
    v_lshrrev_b32 v11, 22, v11
    v_lshl_or_b32 v70, v7, 25, v7
    v_lshrrev_b32 v12, 22, v12
    v_lshl_or_b32 v71, v8, 25, v8
    v_and_or_b32 v68, v68, s37, v17
    v_and_or_b32 v69, v69, s37, v17
    v_and_or_b32 v70, v70, s37, v17
    v_and_or_b32 v71, v71, s37, v17
    v_mad_i32_i24 v44, v9, s96, v44
    v_lshl_add_u32 v68, v9, 18, v68
    v_mad_i32_i24 v45, v10, s96, v45
    v_lshl_add_u32 v69, v10, 18, v69
    v_mad_i32_i24 v46, v11, s96, v46
    v_lshl_add_u32 v70, v11, 18, v70
    v_mad_i32_i24 v47, v12, s96, v47
    v_lshl_add_u32 v71, v12, 18, v71
    s_waitcnt vmcnt(6)
    s_cmp_eq_u32 s36, 1.0
    s_cbranch_scc1 L_p1_kernel_f0_3
    v_lshlrev_b32 v5, 16, v26
    v_and_b32 v6, 0xffff0000, v26
    v_lshlrev_b32 v7, 16, v27
    v_and_b32 v8, 0xffff0000, v27
    v_mul_f32 v5, s36, v5
    v_mul_f32 v6, s36, v6
    v_mul_f32 v7, s36, v7
    v_mul_f32 v8, s36, v8
    v_cvt_pk_bf16_f32 v26, v5, v6
    v_cvt_pk_bf16_f32 v27, v7, v8
L_p1_kernel_f0_3:
    v_lshlrev_b32 v5, 16, v26
    v_and_b32 v6, 0xffff0000, v26
    v_lshlrev_b32 v7, 16, v27
    v_and_b32 v8, 0xffff0000, v27
    v_mul_f32 v5, 0.15915494, v5
    v_mul_f32 v6, 0.15915494, v6
    v_mul_f32 v7, 0.15915494, v7
    v_mul_f32 v8, 0.15915494, v8
    v_fract_f32 v5, v5
    v_fract_f32 v6, v6
    v_fract_f32 v7, v7
    v_fract_f32 v8, v8
    v_cos_f32 v5, v5
    v_cos_f32 v6, v6
    v_cos_f32 v7, v7
    v_cos_f32 v8, v8
    v_mul_f32 v5, 0x03800000, v5
    v_mul_f32 v6, 0x03800000, v6
    v_mul_f32 v7, 0x03800000, v7
    v_mul_f32 v8, 0x03800000, v8
    v_cvt_pk_bf16_f32 v9, v5, v6
    v_cvt_pk_bf16_f32 v10, v7, v8
    v_lshrrev_b32 v5, 5, v9
    v_lshrrev_b32 v6, 5, v10
    v_bfi_b32 v9, s97, v5, v9
    v_bfi_b32 v10, s97, v6, v10
    v_lshl_or_b32 v44, v9, 21, v44
    v_lshlrev_b32 v5, 5, v9
    v_lshl_or_b32 v46, v10, 21, v46
    v_lshlrev_b32 v6, 5, v10
    v_and_or_b32 v45, v5, s95, v45
    v_and_or_b32 v47, v6, s95, v47
    v_and_b32 v80, 0x7fff7fff, v80
    v_and_b32 v81, 0x7fff7fff, v81
    v_and_b32 v82, 0x7fff7fff, v82
    v_and_b32 v83, 0x7fff7fff, v83
    v_and_b32 v84, 0x7fff7fff, v84
    v_and_b32 v85, 0x7fff7fff, v85
    v_and_b32 v86, 0x7fff7fff, v86
    v_and_b32 v87, 0x7fff7fff, v87
    v_pk_max_u16 v80, v80, v84
    v_pk_max_u16 v81, v81, v85
    v_pk_max_u16 v82, v82, v86
    v_pk_max_u16 v83, v83, v87
    v_pk_max_u16 v80, v80, v82
    v_pk_max_u16 v81, v81, v83
    v_pk_max_u16 v80, v80, v81
    v_max_u32_sdwa v80, v80, v80 dst_sel:DWORD dst_unused:UNUSED_PAD src0_sel:WORD_0 src1_sel:WORD_1
    v_mov_b32 v81, 10256
    s_nop 0
    v_max_u32_dpp v80, v80, v80 row_ror:8 row_mask:0xf bank_mask:0xf
    s_nop 1
    v_max_u32_dpp v80, v80, v80 row_ror:4 row_mask:0xf bank_mask:0xf
    s_nop 1
    v_max_u32_dpp v80, v80, v80 row_ror:2 row_mask:0xf bank_mask:0xf
    s_nop 1
    v_max_u32_dpp v80, v80, v80 row_ror:1 row_mask:0xf bank_mask:0xf
    s_mov_b32 exec_lo, 0x00010001
    s_mov_b32 exec_hi, 0x00010001
    ds_max_u32 v81, v80
    s_mov_b64 exec, -1
    s_add_u32 s38, s86, 0
    v_lshlrev_b32 v28, 2, v0
    v_cndmask_b32 v28, -16, v28, s[40:41]
    buffer_load_dword v29, v28, s[12:15], s38 offen nt
    buffer_load_dword v28, v28, s[8:11], s38 offen nt
    s_add_u32 s38, s86, 0
    s_lshr_b32 s38, s38, 1
    v_lshlrev_b32 v19, 1, v0
    v_cndmask_b32 v19, -16, v19, s[40:41]
    buffer_load_ushort v19, v19, s[16:19], s38 offen nt
    s_or_b32 s38, s2, s39
    s_cbranch_scc1 L_p1_kernel_w1
    v_and_b32 v94, 3, v0
    v_lshrrev_b32 v95, 2, v0
    v_mul_u32_u24 v94, 24, v94
    v_add_lshl_u32 v94, v94, v95, 1
    v_lshlrev_b32 v92, 1, v0
    s_mov_b32 exec_hi, 0
    global_store_short v94, v88, s[84:85] offset:-992
    global_store_short v94, v89, s[84:85] offset:-1008
    s_mov_b32 exec_lo, 0xffff
    global_store_short v94, v90, s[84:85] offset:-1024
    global_store_short v94, v91, s[84:85] offset:-1016
    s_mov_b32 exec_lo, 0xff
    global_store_short v92, v93, s[84:85] offset:-832
    s_mov_b64 exec, -1
L_p1_kernel_w1:
    s_waitcnt vmcnt(8)
    v_mul_hi_u32_u24 v5, s32, v72
    v_mul_hi_u32_u24 v6, s32, v73
    v_mul_hi_u32_u24 v7, s32, v74
    v_mul_hi_u32_u24 v8, s32, v75
    v_mad_i32_i24 v72, v5, s33, v72
    v_mad_i32_i24 v73, v6, s33, v73
    v_mad_i32_i24 v74, v7, s33, v74
    v_mad_i32_i24 v75, v8, s33, v75
    s_waitcnt vmcnt(7)
    v_lshrrev_b32 v9, 4, v48
    v_lshrrev_b32 v10, 4, v49
    v_lshrrev_b32 v11, 4, v50
    v_lshrrev_b32 v12, 4, v51
    v_mul_hi_u32_u24 v9, s34, v9
    v_mul_hi_u32_u24 v10, s34, v10
    v_mul_hi_u32_u24 v11, s34, v11
    v_mul_hi_u32_u24 v12, s34, v12
    v_mad_i32_i24 v48, v9, s35, v48
    v_lshl_add_u32 v5, v9, 6, v5
    v_mad_i32_i24 v49, v10, s35, v49
    v_lshl_add_u32 v6, v10, 6, v6
    v_mad_i32_i24 v50, v11, s35, v50
    v_lshl_add_u32 v7, v11, 6, v7
    v_mad_i32_i24 v51, v12, s35, v51
    v_lshl_add_u32 v8, v12, 6, v8
    v_mul_u32_u24 v9, 43691, v48
    v_lshl_add_u32 v48, v72, 7, v48
    v_lshlrev_b32 v5, 2, v5
    v_mul_u32_u24 v10, 43691, v49
    v_lshl_add_u32 v49, v73, 7, v49
    v_lshlrev_b32 v6, 2, v6
    v_mul_u32_u24 v11, 43691, v50
    v_lshl_add_u32 v50, v74, 7, v50
    v_lshlrev_b32 v7, 2, v7
    v_mul_u32_u24 v12, 43691, v51
    v_lshl_add_u32 v51, v75, 7, v51
    v_lshlrev_b32 v8, 2, v8
    ds_add_u32 v5, v3 offset:0
    ds_add_u32 v6, v3 offset:0
    ds_add_u32 v7, v3 offset:0
    ds_add_u32 v8, v3 offset:0
    v_lshrrev_b32 v9, 22, v9
    v_lshl_or_b32 v72, v5, 25, v5
    v_lshrrev_b32 v10, 22, v10
    v_lshl_or_b32 v73, v6, 25, v6
    v_lshrrev_b32 v11, 22, v11
    v_lshl_or_b32 v74, v7, 25, v7
    v_lshrrev_b32 v12, 22, v12
    v_lshl_or_b32 v75, v8, 25, v8
    v_and_or_b32 v72, v72, s37, v17
    v_and_or_b32 v73, v73, s37, v17
    v_and_or_b32 v74, v74, s37, v17
    v_and_or_b32 v75, v75, s37, v17
    v_mad_i32_i24 v48, v9, s96, v48
    v_lshl_add_u32 v72, v9, 18, v72
    v_mad_i32_i24 v49, v10, s96, v49
    v_lshl_add_u32 v73, v10, 18, v73
    v_mad_i32_i24 v50, v11, s96, v50
    v_lshl_add_u32 v74, v11, 18, v74
    v_mad_i32_i24 v51, v12, s96, v51
    v_lshl_add_u32 v75, v12, 18, v75
    s_waitcnt vmcnt(6)
    s_cmp_eq_u32 s36, 1.0
    s_cbranch_scc1 L_p1_kernel_f0_4
    v_lshlrev_b32 v5, 16, v20
    v_and_b32 v6, 0xffff0000, v20
    v_lshlrev_b32 v7, 16, v21
    v_and_b32 v8, 0xffff0000, v21
    v_mul_f32 v5, s36, v5
    v_mul_f32 v6, s36, v6
    v_mul_f32 v7, s36, v7
    v_mul_f32 v8, s36, v8
    v_cvt_pk_bf16_f32 v20, v5, v6
    v_cvt_pk_bf16_f32 v21, v7, v8
L_p1_kernel_f0_4:
    v_lshlrev_b32 v5, 16, v20
    v_and_b32 v6, 0xffff0000, v20
    v_lshlrev_b32 v7, 16, v21
    v_and_b32 v8, 0xffff0000, v21
    v_mul_f32 v5, 0.15915494, v5
    v_mul_f32 v6, 0.15915494, v6
    v_mul_f32 v7, 0.15915494, v7
    v_mul_f32 v8, 0.15915494, v8
    v_fract_f32 v5, v5
    v_fract_f32 v6, v6
    v_fract_f32 v7, v7
    v_fract_f32 v8, v8
    v_cos_f32 v5, v5
    v_cos_f32 v6, v6
    v_cos_f32 v7, v7
    v_cos_f32 v8, v8
    v_mul_f32 v5, 0x03800000, v5
    v_mul_f32 v6, 0x03800000, v6
    v_mul_f32 v7, 0x03800000, v7
    v_mul_f32 v8, 0x03800000, v8
    v_cvt_pk_bf16_f32 v9, v5, v6
    v_cvt_pk_bf16_f32 v10, v7, v8
    v_lshrrev_b32 v5, 5, v9
    v_lshrrev_b32 v6, 5, v10
    v_bfi_b32 v9, s97, v5, v9
    v_bfi_b32 v10, s97, v6, v10
    v_lshl_or_b32 v48, v9, 21, v48
    v_lshlrev_b32 v5, 5, v9
    v_lshl_or_b32 v50, v10, 21, v50
    v_lshlrev_b32 v6, 5, v10
    v_and_or_b32 v49, v5, s95, v49
    v_and_or_b32 v51, v6, s95, v51
    s_waitcnt vmcnt(5)
    v_mul_hi_u32_u24 v5, s32, v76
    v_mul_hi_u32_u24 v6, s32, v77
    v_mul_hi_u32_u24 v7, s32, v78
    v_mul_hi_u32_u24 v8, s32, v79
    v_mad_i32_i24 v76, v5, s33, v76
    v_mad_i32_i24 v77, v6, s33, v77
    v_mad_i32_i24 v78, v7, s33, v78
    v_mad_i32_i24 v79, v8, s33, v79
    s_waitcnt vmcnt(4)
    v_lshrrev_b32 v9, 4, v52
    v_lshrrev_b32 v10, 4, v53
    v_lshrrev_b32 v11, 4, v54
    v_lshrrev_b32 v12, 4, v55
    v_mul_hi_u32_u24 v9, s34, v9
    v_mul_hi_u32_u24 v10, s34, v10
    v_mul_hi_u32_u24 v11, s34, v11
    v_mul_hi_u32_u24 v12, s34, v12
    v_mad_i32_i24 v52, v9, s35, v52
    v_lshl_add_u32 v5, v9, 6, v5
    v_mad_i32_i24 v53, v10, s35, v53
    v_lshl_add_u32 v6, v10, 6, v6
    v_mad_i32_i24 v54, v11, s35, v54
    v_lshl_add_u32 v7, v11, 6, v7
    v_mad_i32_i24 v55, v12, s35, v55
    v_lshl_add_u32 v8, v12, 6, v8
    v_mul_u32_u24 v9, 43691, v52
    v_lshl_add_u32 v52, v76, 7, v52
    v_lshlrev_b32 v5, 2, v5
    v_mul_u32_u24 v10, 43691, v53
    v_lshl_add_u32 v53, v77, 7, v53
    v_lshlrev_b32 v6, 2, v6
    v_mul_u32_u24 v11, 43691, v54
    v_lshl_add_u32 v54, v78, 7, v54
    v_lshlrev_b32 v7, 2, v7
    v_mul_u32_u24 v12, 43691, v55
    v_lshl_add_u32 v55, v79, 7, v55
    v_lshlrev_b32 v8, 2, v8
    ds_add_u32 v5, v3 offset:0
    ds_add_u32 v6, v3 offset:0
    ds_add_u32 v7, v3 offset:0
    ds_add_u32 v8, v3 offset:0
    v_lshrrev_b32 v9, 22, v9
    v_lshl_or_b32 v76, v5, 25, v5
    v_lshrrev_b32 v10, 22, v10
    v_lshl_or_b32 v77, v6, 25, v6
    v_lshrrev_b32 v11, 22, v11
    v_lshl_or_b32 v78, v7, 25, v7
    v_lshrrev_b32 v12, 22, v12
    v_lshl_or_b32 v79, v8, 25, v8
    v_and_or_b32 v76, v76, s37, v17
    v_and_or_b32 v77, v77, s37, v17
    v_and_or_b32 v78, v78, s37, v17
    v_and_or_b32 v79, v79, s37, v17
    v_mad_i32_i24 v52, v9, s96, v52
    v_lshl_add_u32 v76, v9, 18, v76
    v_mad_i32_i24 v53, v10, s96, v53
    v_lshl_add_u32 v77, v10, 18, v77
    v_mad_i32_i24 v54, v11, s96, v54
    v_lshl_add_u32 v78, v11, 18, v78
    v_mad_i32_i24 v55, v12, s96, v55
    v_lshl_add_u32 v79, v12, 18, v79
    s_waitcnt vmcnt(3)
    s_cmp_eq_u32 s36, 1.0
    s_cbranch_scc1 L_p1_kernel_f0_5
    v_lshlrev_b32 v5, 16, v22
    v_and_b32 v6, 0xffff0000, v22
    v_lshlrev_b32 v7, 16, v23
    v_and_b32 v8, 0xffff0000, v23
    v_mul_f32 v5, s36, v5
    v_mul_f32 v6, s36, v6
    v_mul_f32 v7, s36, v7
    v_mul_f32 v8, s36, v8
    v_cvt_pk_bf16_f32 v22, v5, v6
    v_cvt_pk_bf16_f32 v23, v7, v8
L_p1_kernel_f0_5:
    v_lshlrev_b32 v5, 16, v22
    v_and_b32 v6, 0xffff0000, v22
    v_lshlrev_b32 v7, 16, v23
    v_and_b32 v8, 0xffff0000, v23
    v_mul_f32 v5, 0.15915494, v5
    v_mul_f32 v6, 0.15915494, v6
    v_mul_f32 v7, 0.15915494, v7
    v_mul_f32 v8, 0.15915494, v8
    v_fract_f32 v5, v5
    v_fract_f32 v6, v6
    v_fract_f32 v7, v7
    v_fract_f32 v8, v8
    v_cos_f32 v5, v5
    v_cos_f32 v6, v6
    v_cos_f32 v7, v7
    v_cos_f32 v8, v8
    v_mul_f32 v5, 0x03800000, v5
    v_mul_f32 v6, 0x03800000, v6
    v_mul_f32 v7, 0x03800000, v7
    v_mul_f32 v8, 0x03800000, v8
    v_cvt_pk_bf16_f32 v9, v5, v6
    v_cvt_pk_bf16_f32 v10, v7, v8
    v_lshrrev_b32 v5, 5, v9
    v_lshrrev_b32 v6, 5, v10
    v_bfi_b32 v9, s97, v5, v9
    v_bfi_b32 v10, s97, v6, v10
    v_lshl_or_b32 v52, v9, 21, v52
    v_lshlrev_b32 v5, 5, v9
    v_lshl_or_b32 v54, v10, 21, v54
    v_lshlrev_b32 v6, 5, v10
    v_and_or_b32 v53, v5, s95, v53
    v_and_or_b32 v55, v6, s95, v55
    s_mov_b32 s38, 25165824
    buffer_load_dwordx4 v[104:107], v1, s[12:15], s38 offen nt
    buffer_load_dwordx4 v[80:83], v1, s[8:11], s38 offen nt
    s_waitcnt vmcnt(4)
    v_mul_hi_u32_u24 v5, s32, v29
    v_mad_i32_i24 v29, v5, s33, v29
    s_waitcnt vmcnt(3)
    v_lshrrev_b32 v9, 4, v28
    v_mul_hi_u32_u24 v9, s34, v9
    v_mad_i32_i24 v28, v9, s35, v28
    v_lshl_add_u32 v5, v9, 6, v5
    v_mul_u32_u24 v9, 43691, v28
    v_lshl_add_u32 v28, v29, 7, v28
    v_lshlrev_b32 v5, 2, v5
    s_mov_b64 exec, s[40:41]
    ds_add_u32 v5, v3 offset:0
    s_mov_b64 exec, -1
    v_lshrrev_b32 v9, 22, v9
    v_lshl_or_b32 v29, v5, 25, v5
    v_and_or_b32 v29, v29, s37, v17
    v_mad_i32_i24 v28, v9, s96, v28
    v_lshl_add_u32 v29, v9, 18, v29
    s_waitcnt vmcnt(2)
    s_cmp_eq_u32 s36, 1.0
    s_cbranch_scc1 L_p1_kernel_f0_6
    v_lshlrev_b32 v5, 16, v19
    v_mul_f32 v5, s36, v5
    v_cvt_pk_bf16_f32 v19, v5, v5
L_p1_kernel_f0_6:
    v_lshlrev_b32 v5, 16, v19
    v_mul_f32 v5, 0.15915494, v5
    v_fract_f32 v5, v5
    v_cos_f32 v5, v5
    s_nop 0
    v_mul_f32 v5, 0x03800000, v5
    v_cvt_pk_bf16_f32 v9, v5, v5
    v_lshrrev_b32 v5, 5, v9
    v_bfi_b32 v9, s97, v5, v9
    v_lshl_or_b32 v28, v9, 21, v28
    s_mov_b32 s38, 25166848
    buffer_load_dwordx4 v[108:111], v1, s[12:15], s38 offen nt
    buffer_load_dwordx4 v[84:87], v1, s[8:11], s38 offen nt
    s_waitcnt lgkmcnt(0)
    s_barrier
    s_cmp_lt_u32 s39, 4
    s_cbranch_scc1 L_p1_kernel_scan0_s
    v_mov_b32 v6, 0
    v_mov_b32 v7, 0
    v_mov_b32 v8, 0
    v_mov_b32 v9, 0
    ds_write_b128 v1, v[6:9] offset:6176
    ds_write_b128 v1, v[6:9] offset:18464
    ds_write_b128 v1, v[6:9] offset:30752
    s_waitcnt lgkmcnt(0)
    s_branch L_p1_kernel_scan0_a
L_p1_kernel_scan0_s:
    s_mul_i32 s38, s39, 1024
    v_lshl_add_u32 v5, v0, 2, s38
    ds_read_b32 v6, v5 offset:0
    ds_read_b32 v7, v5 offset:256
    ds_read_b32 v8, v5 offset:512
    ds_read_b32 v9, v5 offset:768
    ds_read_b32 v10, v5 offset:1024
    s_waitcnt lgkmcnt(0)
    v_max_u32 v6, 2, v6
    v_max_u32 v7, 2, v7
    v_max_u32 v8, 2, v8
    v_max_u32 v9, 2, v9
    v_max_u32 v10, 2, v10
    v_add_u32_dpp v12, v6, v6 row_shr:1 row_mask:0xf bank_mask:0xf bound_ctrl:0
    v_add_u32_dpp v13, v7, v7 row_shr:1 row_mask:0xf bank_mask:0xf bound_ctrl:0
    v_add_u32_dpp v14, v8, v8 row_shr:1 row_mask:0xf bank_mask:0xf bound_ctrl:0
    v_add_u32_dpp v15, v9, v9 row_shr:1 row_mask:0xf bank_mask:0xf bound_ctrl:0
    v_add_u32_dpp v16, v10, v10 row_shr:1 row_mask:0xf bank_mask:0xf bound_ctrl:0
    v_add_u32_dpp v12, v12, v12 row_shr:2 row_mask:0xf bank_mask:0xf bound_ctrl:0
    v_add_u32_dpp v13, v13, v13 row_shr:2 row_mask:0xf bank_mask:0xf bound_ctrl:0
    v_add_u32_dpp v14, v14, v14 row_shr:2 row_mask:0xf bank_mask:0xf bound_ctrl:0
    v_add_u32_dpp v15, v15, v15 row_shr:2 row_mask:0xf bank_mask:0xf bound_ctrl:0
    v_add_u32_dpp v16, v16, v16 row_shr:2 row_mask:0xf bank_mask:0xf bound_ctrl:0
    v_add_u32_dpp v12, v12, v12 row_shr:4 row_mask:0xf bank_mask:0xf bound_ctrl:0
    v_add_u32_dpp v13, v13, v13 row_shr:4 row_mask:0xf bank_mask:0xf bound_ctrl:0
    v_add_u32_dpp v14, v14, v14 row_shr:4 row_mask:0xf bank_mask:0xf bound_ctrl:0
    v_add_u32_dpp v15, v15, v15 row_shr:4 row_mask:0xf bank_mask:0xf bound_ctrl:0
    v_add_u32_dpp v16, v16, v16 row_shr:4 row_mask:0xf bank_mask:0xf bound_ctrl:0
    v_add_u32_dpp v12, v12, v12 row_shr:8 row_mask:0xf bank_mask:0xf bound_ctrl:0
    v_add_u32_dpp v13, v13, v13 row_shr:8 row_mask:0xf bank_mask:0xf bound_ctrl:0
    v_add_u32_dpp v14, v14, v14 row_shr:8 row_mask:0xf bank_mask:0xf bound_ctrl:0
    v_add_u32_dpp v15, v15, v15 row_shr:8 row_mask:0xf bank_mask:0xf bound_ctrl:0
    v_add_u32_dpp v16, v16, v16 row_shr:8 row_mask:0xf bank_mask:0xf bound_ctrl:0
    v_add_u32_dpp v12, v12, v12 row_bcast:15 row_mask:0xa bank_mask:0xf
    v_add_u32_dpp v13, v13, v13 row_bcast:15 row_mask:0xa bank_mask:0xf
    v_add_u32_dpp v14, v14, v14 row_bcast:15 row_mask:0xa bank_mask:0xf
    v_add_u32_dpp v15, v15, v15 row_bcast:15 row_mask:0xa bank_mask:0xf
    v_add_u32_dpp v16, v16, v16 row_bcast:15 row_mask:0xa bank_mask:0xf
    v_add_u32_dpp v12, v12, v12 row_bcast:31 row_mask:0xc bank_mask:0xf
    v_add_u32_dpp v13, v13, v13 row_bcast:31 row_mask:0xc bank_mask:0xf
    v_add_u32_dpp v14, v14, v14 row_bcast:31 row_mask:0xc bank_mask:0xf
    v_add_u32_dpp v15, v15, v15 row_bcast:31 row_mask:0xc bank_mask:0xf
    v_add_u32_dpp v16, v16, v16 row_bcast:31 row_mask:0xc bank_mask:0xf
    v_readlane_b32 s4, v12, 63
    v_readlane_b32 s5, v13, 63
    v_readlane_b32 s6, v14, 63
    v_readlane_b32 s7, v15, 63
    v_readlane_b32 s42, v16, 63
    v_sub_u32 v12, v12, v6
    v_sub_u32 v13, v13, v7
    v_sub_u32 v14, v14, v8
    v_sub_u32 v15, v15, v9
    v_sub_u32 v16, v16, v10
    s_add_u32 s5, s5, s4
    s_add_u32 s6, s6, s5
    s_add_u32 s7, s7, s6
    s_add_u32 s42, s42, s7
    v_add_u32 v13, s4, v13
    v_add_u32 v14, s5, v14
    v_add_u32 v15, s6, v15
    v_add_u32 v16, s7, v16
    s_lshl_b32 s38, s39, 2
    v_mov_b32 v18, s42
    v_mov_b32 v19, s38
    ds_write_b32 v19, v18 offset:10240
    s_waitcnt lgkmcnt(0)
L_p1_kernel_scan0_a:
    s_barrier
    s_cmp_ge_u32 s39, 4
    s_cbranch_scc1 L_p1_kernel_scan0_b
    v_and_b32 v19, 3, v0
    v_cmp_gt_u32 vcc, s39, v19
    v_lshlrev_b32 v18, 2, v19
    ds_read_b32 v18, v18 offset:10240
    s_waitcnt lgkmcnt(0)
    v_cndmask_b32 v18, 0, v18, vcc
    s_nop 1
    v_add_u32_dpp v18, v18, v18 quad_perm:[1,0,3,2] row_mask:0xf bank_mask:0xf
    s_nop 1
    v_add_u32_dpp v18, v18, v18 quad_perm:[2,3,0,1] row_mask:0xf bank_mask:0xf
    v_add_u32 v12, v18, v12
    v_add_u32 v13, v18, v13
    v_add_u32 v14, v18, v14
    v_add_u32 v15, v18, v15
    v_add_u32 v16, v18, v16
    v_add3_u32 v6, v12, v6, 2
    v_mul_u32_u24 v12, v4, v12
    v_mul_u32_u24 v6, v4, v6
    v_lshrrev_b32 v18, 16, v12
    v_sub_u32_sdwa v6, v6, v18 dst_sel:DWORD dst_unused:UNUSED_PAD src0_sel:WORD_1 src1_sel:DWORD
    v_lshl_or_b32 v6, v6, 16, v18
    v_add3_u32 v7, v13, v7, 2
    v_mul_u32_u24 v13, v4, v13
    v_mul_u32_u24 v7, v4, v7
    v_lshrrev_b32 v18, 16, v13
    v_sub_u32_sdwa v7, v7, v18 dst_sel:DWORD dst_unused:UNUSED_PAD src0_sel:WORD_1 src1_sel:DWORD
    v_lshl_or_b32 v7, v7, 16, v18
    v_add3_u32 v8, v14, v8, 2
    v_mul_u32_u24 v14, v4, v14
    v_mul_u32_u24 v8, v4, v8
    v_lshrrev_b32 v18, 16, v14
    v_sub_u32_sdwa v8, v8, v18 dst_sel:DWORD dst_unused:UNUSED_PAD src0_sel:WORD_1 src1_sel:DWORD
    v_lshl_or_b32 v8, v8, 16, v18
    v_add3_u32 v9, v15, v9, 2
    v_mul_u32_u24 v15, v4, v15
    v_mul_u32_u24 v9, v4, v9
    v_lshrrev_b32 v18, 16, v15
    v_sub_u32_sdwa v9, v9, v18 dst_sel:DWORD dst_unused:UNUSED_PAD src0_sel:WORD_1 src1_sel:DWORD
    v_lshl_or_b32 v9, v9, 16, v18
    v_add3_u32 v10, v16, v10, 2
    v_mul_u32_u24 v16, v4, v16
    v_mul_u32_u24 v10, v4, v10
    v_lshrrev_b32 v18, 16, v16
    v_sub_u32_sdwa v10, v10, v18 dst_sel:DWORD dst_unused:UNUSED_PAD src0_sel:WORD_1 src1_sel:DWORD
    v_lshl_or_b32 v10, v10, 16, v18
    ds_write_b32 v5, v12 offset:0
    ds_write_b32 v5, v13 offset:256
    ds_write_b32 v5, v14 offset:512
    ds_write_b32 v5, v15 offset:768
    ds_write_b32 v5, v16 offset:1024
    v_mul_u32_u24 v18, 40, v0
    s_mov_b32 s38, 0
    buffer_store_dwordx4 v[6:9], v18, s[28:31], s38 offen
    buffer_store_dword v10, v18, s[28:31], s38 offen offset:16
    s_waitcnt lgkmcnt(0)
L_p1_kernel_scan0_b:
    s_barrier
    v_and_b32 v5, 0xffff, v29
    s_mov_b64 exec, s[40:41]
    ds_add_rtn_u32 v5, v5, v4 offset:0
    s_mov_b64 exec, -1
    v_and_b32 v6, 0xffff, v56
    ds_add_rtn_u32 v6, v6, v4 offset:0
    v_and_b32 v7, 0xffff, v57
    ds_add_rtn_u32 v7, v7, v4 offset:0
    v_and_b32 v8, 0xffff, v58
    ds_add_rtn_u32 v8, v8, v4 offset:0
    v_and_b32 v9, 0xffff, v59
    ds_add_rtn_u32 v9, v9, v4 offset:0
    s_waitcnt lgkmcnt(4)
    v_mul_u32_u24_sdwa v10, 3, v5 dst_sel:DWORD dst_unused:UNUSED_PAD src0_sel:DWORD src1_sel:WORD_0
    v_lshlrev_b32_sdwa v11, 2, v5 dst_sel:DWORD dst_unused:UNUSED_PAD src0_sel:DWORD src1_sel:WORD_1
    v_mul_u32_u24_sdwa v12, s87, v10 dst_sel:DWORD dst_unused:UNUSED_PAD src0_sel:DWORD src1_sel:WORD_1
    v_mul_u32_u24_sdwa v10, 10, v10 dst_sel:DWORD dst_unused:UNUSED_PAD src0_sel:DWORD src1_sel:WORD_1
    v_add_u32 v12, v12, v11
    v_lshlrev_b32_sdwa v10, v10, v29 dst_sel:DWORD dst_unused:UNUSED_PAD src0_sel:DWORD src1_sel:WORD_1
    s_mov_b64 exec, s[40:41]
    ds_write_b32 v12, v28 offset:47136
    ds_or_b32 v11, v10 offset:10272
    s_mov_b64 exec, -1
    v_and_b32 v5, 0xffff, v60
    ds_add_rtn_u32 v5, v5, v4 offset:0
    s_waitcnt lgkmcnt(6)
    v_mul_u32_u24_sdwa v13, 3, v6 dst_sel:DWORD dst_unused:UNUSED_PAD src0_sel:DWORD src1_sel:WORD_0
    v_lshlrev_b32_sdwa v14, 2, v6 dst_sel:DWORD dst_unused:UNUSED_PAD src0_sel:DWORD src1_sel:WORD_1
    v_mul_u32_u24_sdwa v15, s87, v13 dst_sel:DWORD dst_unused:UNUSED_PAD src0_sel:DWORD src1_sel:WORD_1
    v_mul_u32_u24_sdwa v13, 10, v13 dst_sel:DWORD dst_unused:UNUSED_PAD src0_sel:DWORD src1_sel:WORD_1
    v_add_u32 v15, v15, v14
    v_lshlrev_b32_sdwa v13, v13, v56 dst_sel:DWORD dst_unused:UNUSED_PAD src0_sel:DWORD src1_sel:WORD_1
    ds_write_b32 v15, v32 offset:47136
    ds_or_b32 v14, v13 offset:10272
    s_mov_b32 s38, 25167872
    buffer_load_dwordx4 v[112:115], v1, s[12:15], s38 offen nt
    buffer_load_dwordx4 v[88:91], v1, s[8:11], s38 offen nt
    v_and_b32 v6, 0xffff, v61
    ds_add_rtn_u32 v6, v6, v4 offset:0
    s_waitcnt lgkmcnt(8)
    v_mul_u32_u24_sdwa v10, 3, v7 dst_sel:DWORD dst_unused:UNUSED_PAD src0_sel:DWORD src1_sel:WORD_0
    v_lshlrev_b32_sdwa v11, 2, v7 dst_sel:DWORD dst_unused:UNUSED_PAD src0_sel:DWORD src1_sel:WORD_1
    v_mul_u32_u24_sdwa v12, s87, v10 dst_sel:DWORD dst_unused:UNUSED_PAD src0_sel:DWORD src1_sel:WORD_1
    v_mul_u32_u24_sdwa v10, 10, v10 dst_sel:DWORD dst_unused:UNUSED_PAD src0_sel:DWORD src1_sel:WORD_1
    v_add_u32 v12, v12, v11
    v_lshlrev_b32_sdwa v10, v10, v57 dst_sel:DWORD dst_unused:UNUSED_PAD src0_sel:DWORD src1_sel:WORD_1
    ds_write_b32 v12, v33 offset:47136
    ds_or_b32 v11, v10 offset:10272
    v_and_b32 v7, 0xffff, v62
    ds_add_rtn_u32 v7, v7, v4 offset:0
    s_waitcnt lgkmcnt(10)
    v_mul_u32_u24_sdwa v13, 3, v8 dst_sel:DWORD dst_unused:UNUSED_PAD src0_sel:DWORD src1_sel:WORD_0
    v_lshlrev_b32_sdwa v14, 2, v8 dst_sel:DWORD dst_unused:UNUSED_PAD src0_sel:DWORD src1_sel:WORD_1
    v_mul_u32_u24_sdwa v15, s87, v13 dst_sel:DWORD dst_unused:UNUSED_PAD src0_sel:DWORD src1_sel:WORD_1
    v_mul_u32_u24_sdwa v13, 10, v13 dst_sel:DWORD dst_unused:UNUSED_PAD src0_sel:DWORD src1_sel:WORD_1
    v_add_u32 v15, v15, v14
    v_lshlrev_b32_sdwa v13, v13, v58 dst_sel:DWORD dst_unused:UNUSED_PAD src0_sel:DWORD src1_sel:WORD_1
    ds_write_b32 v15, v34 offset:47136
    ds_or_b32 v14, v13 offset:10272
    v_and_b32 v8, 0xffff, v63
    ds_add_rtn_u32 v8, v8, v4 offset:0
    s_waitcnt lgkmcnt(12)
    v_mul_u32_u24_sdwa v10, 3, v9 dst_sel:DWORD dst_unused:UNUSED_PAD src0_sel:DWORD src1_sel:WORD_0
    v_lshlrev_b32_sdwa v11, 2, v9 dst_sel:DWORD dst_unused:UNUSED_PAD src0_sel:DWORD src1_sel:WORD_1
    v_mul_u32_u24_sdwa v12, s87, v10 dst_sel:DWORD dst_unused:UNUSED_PAD src0_sel:DWORD src1_sel:WORD_1
    v_mul_u32_u24_sdwa v10, 10, v10 dst_sel:DWORD dst_unused:UNUSED_PAD src0_sel:DWORD src1_sel:WORD_1
    v_add_u32 v12, v12, v11
    v_lshlrev_b32_sdwa v10, v10, v59 dst_sel:DWORD dst_unused:UNUSED_PAD src0_sel:DWORD src1_sel:WORD_1
    ds_write_b32 v12, v35 offset:47136
    ds_or_b32 v11, v10 offset:10272
    s_waitcnt vmcnt(5)
    v_mul_hi_u32_u24 v20, s32, v104
    v_mul_hi_u32_u24 v21, s32, v105
    v_mul_hi_u32_u24 v22, s32, v106
    v_mul_hi_u32_u24 v23, s32, v107
    v_mad_i32_i24 v104, v20, s33, v104
    v_mad_i32_i24 v105, v21, s33, v105
    v_mad_i32_i24 v106, v22, s33, v106
    v_mad_i32_i24 v107, v23, s33, v107
    s_waitcnt vmcnt(4)
    v_lshrrev_b32 v24, 4, v80
    v_lshrrev_b32 v25, 4, v81
    v_lshrrev_b32 v26, 4, v82
    v_lshrrev_b32 v27, 4, v83
    v_mul_hi_u32_u24 v24, s34, v24
    v_mul_hi_u32_u24 v25, s34, v25
    v_mul_hi_u32_u24 v26, s34, v26
    v_mul_hi_u32_u24 v27, s34, v27
    v_mad_i32_i24 v80, v24, s35, v80
    v_lshl_add_u32 v20, v24, 6, v20
    v_mad_i32_i24 v81, v25, s35, v81
    v_lshl_add_u32 v21, v25, 6, v21
    v_mad_i32_i24 v82, v26, s35, v82
    v_lshl_add_u32 v22, v26, 6, v22
    v_mad_i32_i24 v83, v27, s35, v83
    v_lshl_add_u32 v23, v27, 6, v23
    v_mul_u32_u24 v24, 43691, v80
    v_lshl_add_u32 v80, v104, 7, v80
    v_lshlrev_b32 v20, 2, v20
    v_mul_u32_u24 v25, 43691, v81
    v_lshl_add_u32 v81, v105, 7, v81
    v_lshlrev_b32 v21, 2, v21
    v_mul_u32_u24 v26, 43691, v82
    v_lshl_add_u32 v82, v106, 7, v82
    v_lshlrev_b32 v22, 2, v22
    v_mul_u32_u24 v27, 43691, v83
    v_lshl_add_u32 v83, v107, 7, v83
    v_lshlrev_b32 v23, 2, v23
    ds_add_u32 v20, v3 offset:5120
    ds_add_u32 v21, v3 offset:5120
    ds_add_u32 v22, v3 offset:5120
    ds_add_u32 v23, v3 offset:5120
    v_lshrrev_b32 v24, 22, v24
    v_lshl_or_b32 v104, v20, 25, v20
    v_lshrrev_b32 v25, 22, v25
    v_lshl_or_b32 v105, v21, 25, v21
    v_lshrrev_b32 v26, 22, v26
    v_lshl_or_b32 v106, v22, 25, v22
    v_lshrrev_b32 v27, 22, v27
    v_lshl_or_b32 v107, v23, 25, v23
    v_and_or_b32 v104, v104, s37, v17
    v_and_or_b32 v105, v105, s37, v17
    v_and_or_b32 v106, v106, s37, v17
    v_and_or_b32 v107, v107, s37, v17
    v_mad_i32_i24 v80, v24, s96, v80
    v_lshl_add_u32 v104, v24, 18, v104
    v_mad_i32_i24 v81, v25, s96, v81
    v_lshl_add_u32 v105, v25, 18, v105
    v_mad_i32_i24 v82, v26, s96, v82
    v_lshl_add_u32 v106, v26, 18, v106
    v_mad_i32_i24 v83, v27, s96, v83
    v_lshl_add_u32 v107, v27, 18, v107
    v_and_b32 v9, 0xffff, v64
    ds_add_rtn_u32 v9, v9, v4 offset:0
    s_waitcnt lgkmcnt(15)
    v_mul_u32_u24_sdwa v13, 3, v5 dst_sel:DWORD dst_unused:UNUSED_PAD src0_sel:DWORD src1_sel:WORD_0
    v_lshlrev_b32_sdwa v14, 2, v5 dst_sel:DWORD dst_unused:UNUSED_PAD src0_sel:DWORD src1_sel:WORD_1
    v_mul_u32_u24_sdwa v15, s87, v13 dst_sel:DWORD dst_unused:UNUSED_PAD src0_sel:DWORD src1_sel:WORD_1
    v_mul_u32_u24_sdwa v13, 10, v13 dst_sel:DWORD dst_unused:UNUSED_PAD src0_sel:DWORD src1_sel:WORD_1
    v_add_u32 v15, v15, v14
    v_lshlrev_b32_sdwa v13, v13, v60 dst_sel:DWORD dst_unused:UNUSED_PAD src0_sel:DWORD src1_sel:WORD_1
    ds_write_b32 v15, v36 offset:47136
    ds_or_b32 v14, v13 offset:10272
    v_and_b32 v5, 0xffff, v65
    ds_add_rtn_u32 v5, v5, v4 offset:0
    s_waitcnt lgkmcnt(15)
    v_mul_u32_u24_sdwa v10, 3, v6 dst_sel:DWORD dst_unused:UNUSED_PAD src0_sel:DWORD src1_sel:WORD_0
    v_lshlrev_b32_sdwa v11, 2, v6 dst_sel:DWORD dst_unused:UNUSED_PAD src0_sel:DWORD src1_sel:WORD_1
    v_mul_u32_u24_sdwa v12, s87, v10 dst_sel:DWORD dst_unused:UNUSED_PAD src0_sel:DWORD src1_sel:WORD_1
    v_mul_u32_u24_sdwa v10, 10, v10 dst_sel:DWORD dst_unused:UNUSED_PAD src0_sel:DWORD src1_sel:WORD_1
    v_add_u32 v12, v12, v11
    v_lshlrev_b32_sdwa v10, v10, v61 dst_sel:DWORD dst_unused:UNUSED_PAD src0_sel:DWORD src1_sel:WORD_1
    ds_write_b32 v12, v37 offset:47136
    ds_or_b32 v11, v10 offset:10272
    v_and_b32 v6, 0xffff, v66
    ds_add_rtn_u32 v6, v6, v4 offset:0
    s_waitcnt lgkmcnt(15)
    v_mul_u32_u24_sdwa v13, 3, v7 dst_sel:DWORD dst_unused:UNUSED_PAD src0_sel:DWORD src1_sel:WORD_0
    v_lshlrev_b32_sdwa v14, 2, v7 dst_sel:DWORD dst_unused:UNUSED_PAD src0_sel:DWORD src1_sel:WORD_1
    v_mul_u32_u24_sdwa v15, s87, v13 dst_sel:DWORD dst_unused:UNUSED_PAD src0_sel:DWORD src1_sel:WORD_1
    v_mul_u32_u24_sdwa v13, 10, v13 dst_sel:DWORD dst_unused:UNUSED_PAD src0_sel:DWORD src1_sel:WORD_1
    v_add_u32 v15, v15, v14
    v_lshlrev_b32_sdwa v13, v13, v62 dst_sel:DWORD dst_unused:UNUSED_PAD src0_sel:DWORD src1_sel:WORD_1
    ds_write_b32 v15, v38 offset:47136
    ds_or_b32 v14, v13 offset:10272
    s_mov_b32 s38, 25168896
    buffer_load_dwordx4 v[116:119], v1, s[12:15], s38 offen nt
    buffer_load_dwordx4 v[92:95], v1, s[8:11], s38 offen nt
    v_and_b32 v7, 0xffff, v67
    ds_add_rtn_u32 v7, v7, v4 offset:0
    s_waitcnt lgkmcnt(15)
    v_mul_u32_u24_sdwa v10, 3, v8 dst_sel:DWORD dst_unused:UNUSED_PAD src0_sel:DWORD src1_sel:WORD_0
    v_lshlrev_b32_sdwa v11, 2, v8 dst_sel:DWORD dst_unused:UNUSED_PAD src0_sel:DWORD src1_sel:WORD_1
    v_mul_u32_u24_sdwa v12, s87, v10 dst_sel:DWORD dst_unused:UNUSED_PAD src0_sel:DWORD src1_sel:WORD_1
    v_mul_u32_u24_sdwa v10, 10, v10 dst_sel:DWORD dst_unused:UNUSED_PAD src0_sel:DWORD src1_sel:WORD_1
    v_add_u32 v12, v12, v11
    v_lshlrev_b32_sdwa v10, v10, v63 dst_sel:DWORD dst_unused:UNUSED_PAD src0_sel:DWORD src1_sel:WORD_1
    ds_write_b32 v12, v39 offset:47136
    ds_or_b32 v11, v10 offset:10272
    v_and_b32 v8, 0xffff, v68
    ds_add_rtn_u32 v8, v8, v4 offset:0
    s_waitcnt lgkmcnt(12)
    v_mul_u32_u24_sdwa v13, 3, v9 dst_sel:DWORD dst_unused:UNUSED_PAD src0_sel:DWORD src1_sel:WORD_0
    v_lshlrev_b32_sdwa v14, 2, v9 dst_sel:DWORD dst_unused:UNUSED_PAD src0_sel:DWORD src1_sel:WORD_1
    v_mul_u32_u24_sdwa v15, s87, v13 dst_sel:DWORD dst_unused:UNUSED_PAD src0_sel:DWORD src1_sel:WORD_1
    v_mul_u32_u24_sdwa v13, 10, v13 dst_sel:DWORD dst_unused:UNUSED_PAD src0_sel:DWORD src1_sel:WORD_1
    v_add_u32 v15, v15, v14
    v_lshlrev_b32_sdwa v13, v13, v64 dst_sel:DWORD dst_unused:UNUSED_PAD src0_sel:DWORD src1_sel:WORD_1
    ds_write_b32 v15, v40 offset:47136
    ds_or_b32 v14, v13 offset:10272
    v_and_b32 v9, 0xffff, v69
    ds_add_rtn_u32 v9, v9, v4 offset:0
    s_waitcnt lgkmcnt(12)
    v_mul_u32_u24_sdwa v10, 3, v5 dst_sel:DWORD dst_unused:UNUSED_PAD src0_sel:DWORD src1_sel:WORD_0
    v_lshlrev_b32_sdwa v11, 2, v5 dst_sel:DWORD dst_unused:UNUSED_PAD src0_sel:DWORD src1_sel:WORD_1
    v_mul_u32_u24_sdwa v12, s87, v10 dst_sel:DWORD dst_unused:UNUSED_PAD src0_sel:DWORD src1_sel:WORD_1
    v_mul_u32_u24_sdwa v10, 10, v10 dst_sel:DWORD dst_unused:UNUSED_PAD src0_sel:DWORD src1_sel:WORD_1
    v_add_u32 v12, v12, v11
    v_lshlrev_b32_sdwa v10, v10, v65 dst_sel:DWORD dst_unused:UNUSED_PAD src0_sel:DWORD src1_sel:WORD_1
    ds_write_b32 v12, v41 offset:47136
    ds_or_b32 v11, v10 offset:10272
    v_and_b32 v5, 0xffff, v70
    ds_add_rtn_u32 v5, v5, v4 offset:0
    s_waitcnt lgkmcnt(12)
    v_mul_u32_u24_sdwa v13, 3, v6 dst_sel:DWORD dst_unused:UNUSED_PAD src0_sel:DWORD src1_sel:WORD_0
    v_lshlrev_b32_sdwa v14, 2, v6 dst_sel:DWORD dst_unused:UNUSED_PAD src0_sel:DWORD src1_sel:WORD_1
    v_mul_u32_u24_sdwa v15, s87, v13 dst_sel:DWORD dst_unused:UNUSED_PAD src0_sel:DWORD src1_sel:WORD_1
    v_mul_u32_u24_sdwa v13, 10, v13 dst_sel:DWORD dst_unused:UNUSED_PAD src0_sel:DWORD src1_sel:WORD_1
    v_add_u32 v15, v15, v14
    v_lshlrev_b32_sdwa v13, v13, v66 dst_sel:DWORD dst_unused:UNUSED_PAD src0_sel:DWORD src1_sel:WORD_1
    ds_write_b32 v15, v42 offset:47136
    ds_or_b32 v14, v13 offset:10272
    v_and_b32 v6, 0xffff, v71
    ds_add_rtn_u32 v6, v6, v4 offset:0
    s_waitcnt lgkmcnt(12)
    v_mul_u32_u24_sdwa v10, 3, v7 dst_sel:DWORD dst_unused:UNUSED_PAD src0_sel:DWORD src1_sel:WORD_0
    v_lshlrev_b32_sdwa v11, 2, v7 dst_sel:DWORD dst_unused:UNUSED_PAD src0_sel:DWORD src1_sel:WORD_1
    v_mul_u32_u24_sdwa v12, s87, v10 dst_sel:DWORD dst_unused:UNUSED_PAD src0_sel:DWORD src1_sel:WORD_1
    v_mul_u32_u24_sdwa v10, 10, v10 dst_sel:DWORD dst_unused:UNUSED_PAD src0_sel:DWORD src1_sel:WORD_1
    v_add_u32 v12, v12, v11
    v_lshlrev_b32_sdwa v10, v10, v67 dst_sel:DWORD dst_unused:UNUSED_PAD src0_sel:DWORD src1_sel:WORD_1
    ds_write_b32 v12, v43 offset:47136
    ds_or_b32 v11, v10 offset:10272
    s_waitcnt vmcnt(5)
    v_mul_hi_u32_u24 v20, s32, v108
    v_mul_hi_u32_u24 v21, s32, v109
    v_mul_hi_u32_u24 v22, s32, v110
    v_mul_hi_u32_u24 v23, s32, v111
    v_mad_i32_i24 v108, v20, s33, v108
    v_mad_i32_i24 v109, v21, s33, v109
    v_mad_i32_i24 v110, v22, s33, v110
    v_mad_i32_i24 v111, v23, s33, v111
    s_waitcnt vmcnt(4)
    v_lshrrev_b32 v24, 4, v84
    v_lshrrev_b32 v25, 4, v85
    v_lshrrev_b32 v26, 4, v86
    v_lshrrev_b32 v27, 4, v87
    v_mul_hi_u32_u24 v24, s34, v24
    v_mul_hi_u32_u24 v25, s34, v25
    v_mul_hi_u32_u24 v26, s34, v26
    v_mul_hi_u32_u24 v27, s34, v27
    v_mad_i32_i24 v84, v24, s35, v84
    v_lshl_add_u32 v20, v24, 6, v20
    v_mad_i32_i24 v85, v25, s35, v85
    v_lshl_add_u32 v21, v25, 6, v21
    v_mad_i32_i24 v86, v26, s35, v86
    v_lshl_add_u32 v22, v26, 6, v22
    v_mad_i32_i24 v87, v27, s35, v87
    v_lshl_add_u32 v23, v27, 6, v23
    v_mul_u32_u24 v24, 43691, v84
    v_lshl_add_u32 v84, v108, 7, v84
    v_lshlrev_b32 v20, 2, v20
    v_mul_u32_u24 v25, 43691, v85
    v_lshl_add_u32 v85, v109, 7, v85
    v_lshlrev_b32 v21, 2, v21
    v_mul_u32_u24 v26, 43691, v86
    v_lshl_add_u32 v86, v110, 7, v86
    v_lshlrev_b32 v22, 2, v22
    v_mul_u32_u24 v27, 43691, v87
    v_lshl_add_u32 v87, v111, 7, v87
    v_lshlrev_b32 v23, 2, v23
    ds_add_u32 v20, v3 offset:5120
    ds_add_u32 v21, v3 offset:5120
    ds_add_u32 v22, v3 offset:5120
    ds_add_u32 v23, v3 offset:5120
    v_lshrrev_b32 v24, 22, v24
    v_lshl_or_b32 v108, v20, 25, v20
    v_lshrrev_b32 v25, 22, v25
    v_lshl_or_b32 v109, v21, 25, v21
    v_lshrrev_b32 v26, 22, v26
    v_lshl_or_b32 v110, v22, 25, v22
    v_lshrrev_b32 v27, 22, v27
    v_lshl_or_b32 v111, v23, 25, v23
    v_and_or_b32 v108, v108, s37, v17
    v_and_or_b32 v109, v109, s37, v17
    v_and_or_b32 v110, v110, s37, v17
    v_and_or_b32 v111, v111, s37, v17
    v_mad_i32_i24 v84, v24, s96, v84
    v_lshl_add_u32 v108, v24, 18, v108
    v_mad_i32_i24 v85, v25, s96, v85
    v_lshl_add_u32 v109, v25, 18, v109
    v_mad_i32_i24 v86, v26, s96, v86
    v_lshl_add_u32 v110, v26, 18, v110
    v_mad_i32_i24 v87, v27, s96, v87
    v_lshl_add_u32 v111, v27, 18, v111
    v_and_b32 v7, 0xffff, v72
    ds_add_rtn_u32 v7, v7, v4 offset:0
    s_waitcnt lgkmcnt(15)
    v_mul_u32_u24_sdwa v13, 3, v8 dst_sel:DWORD dst_unused:UNUSED_PAD src0_sel:DWORD src1_sel:WORD_0
    v_lshlrev_b32_sdwa v14, 2, v8 dst_sel:DWORD dst_unused:UNUSED_PAD src0_sel:DWORD src1_sel:WORD_1
    v_mul_u32_u24_sdwa v15, s87, v13 dst_sel:DWORD dst_unused:UNUSED_PAD src0_sel:DWORD src1_sel:WORD_1
    v_mul_u32_u24_sdwa v13, 10, v13 dst_sel:DWORD dst_unused:UNUSED_PAD src0_sel:DWORD src1_sel:WORD_1
    v_add_u32 v15, v15, v14
    v_lshlrev_b32_sdwa v13, v13, v68 dst_sel:DWORD dst_unused:UNUSED_PAD src0_sel:DWORD src1_sel:WORD_1
    ds_write_b32 v15, v44 offset:47136
    ds_or_b32 v14, v13 offset:10272
    s_mov_b32 s38, 25169920
    buffer_load_dwordx4 v[120:123], v1, s[12:15], s38 offen nt
    buffer_load_dwordx4 v[96:99], v1, s[8:11], s38 offen nt
    v_and_b32 v8, 0xffff, v73
    ds_add_rtn_u32 v8, v8, v4 offset:0
    s_waitcnt lgkmcnt(15)
    v_mul_u32_u24_sdwa v10, 3, v9 dst_sel:DWORD dst_unused:UNUSED_PAD src0_sel:DWORD src1_sel:WORD_0
    v_lshlrev_b32_sdwa v11, 2, v9 dst_sel:DWORD dst_unused:UNUSED_PAD src0_sel:DWORD src1_sel:WORD_1
    v_mul_u32_u24_sdwa v12, s87, v10 dst_sel:DWORD dst_unused:UNUSED_PAD src0_sel:DWORD src1_sel:WORD_1
    v_mul_u32_u24_sdwa v10, 10, v10 dst_sel:DWORD dst_unused:UNUSED_PAD src0_sel:DWORD src1_sel:WORD_1
    v_add_u32 v12, v12, v11
    v_lshlrev_b32_sdwa v10, v10, v69 dst_sel:DWORD dst_unused:UNUSED_PAD src0_sel:DWORD src1_sel:WORD_1
    ds_write_b32 v12, v45 offset:47136
    ds_or_b32 v11, v10 offset:10272
    v_and_b32 v9, 0xffff, v74
    ds_add_rtn_u32 v9, v9, v4 offset:0
    s_waitcnt lgkmcnt(15)
    v_mul_u32_u24_sdwa v13, 3, v5 dst_sel:DWORD dst_unused:UNUSED_PAD src0_sel:DWORD src1_sel:WORD_0
    v_lshlrev_b32_sdwa v14, 2, v5 dst_sel:DWORD dst_unused:UNUSED_PAD src0_sel:DWORD src1_sel:WORD_1
    v_mul_u32_u24_sdwa v15, s87, v13 dst_sel:DWORD dst_unused:UNUSED_PAD src0_sel:DWORD src1_sel:WORD_1
    v_mul_u32_u24_sdwa v13, 10, v13 dst_sel:DWORD dst_unused:UNUSED_PAD src0_sel:DWORD src1_sel:WORD_1
    v_add_u32 v15, v15, v14
    v_lshlrev_b32_sdwa v13, v13, v70 dst_sel:DWORD dst_unused:UNUSED_PAD src0_sel:DWORD src1_sel:WORD_1
    ds_write_b32 v15, v46 offset:47136
    ds_or_b32 v14, v13 offset:10272
    v_and_b32 v5, 0xffff, v75
    ds_add_rtn_u32 v5, v5, v4 offset:0
    s_waitcnt lgkmcnt(15)
    v_mul_u32_u24_sdwa v10, 3, v6 dst_sel:DWORD dst_unused:UNUSED_PAD src0_sel:DWORD src1_sel:WORD_0
    v_lshlrev_b32_sdwa v11, 2, v6 dst_sel:DWORD dst_unused:UNUSED_PAD src0_sel:DWORD src1_sel:WORD_1
    v_mul_u32_u24_sdwa v12, s87, v10 dst_sel:DWORD dst_unused:UNUSED_PAD src0_sel:DWORD src1_sel:WORD_1
    v_mul_u32_u24_sdwa v10, 10, v10 dst_sel:DWORD dst_unused:UNUSED_PAD src0_sel:DWORD src1_sel:WORD_1
    v_add_u32 v12, v12, v11
    v_lshlrev_b32_sdwa v10, v10, v71 dst_sel:DWORD dst_unused:UNUSED_PAD src0_sel:DWORD src1_sel:WORD_1
    ds_write_b32 v12, v47 offset:47136
    ds_or_b32 v11, v10 offset:10272
    v_and_b32 v6, 0xffff, v76
    ds_add_rtn_u32 v6, v6, v4 offset:0
    s_waitcnt lgkmcnt(12)
    v_mul_u32_u24_sdwa v13, 3, v7 dst_sel:DWORD dst_unused:UNUSED_PAD src0_sel:DWORD src1_sel:WORD_0
    v_lshlrev_b32_sdwa v14, 2, v7 dst_sel:DWORD dst_unused:UNUSED_PAD src0_sel:DWORD src1_sel:WORD_1
    v_mul_u32_u24_sdwa v15, s87, v13 dst_sel:DWORD dst_unused:UNUSED_PAD src0_sel:DWORD src1_sel:WORD_1
    v_mul_u32_u24_sdwa v13, 10, v13 dst_sel:DWORD dst_unused:UNUSED_PAD src0_sel:DWORD src1_sel:WORD_1
    v_add_u32 v15, v15, v14
    v_lshlrev_b32_sdwa v13, v13, v72 dst_sel:DWORD dst_unused:UNUSED_PAD src0_sel:DWORD src1_sel:WORD_1
    ds_write_b32 v15, v48 offset:47136
    ds_or_b32 v14, v13 offset:10272
    v_and_b32 v7, 0xffff, v77
    ds_add_rtn_u32 v7, v7, v4 offset:0
    s_waitcnt lgkmcnt(12)
    v_mul_u32_u24_sdwa v10, 3, v8 dst_sel:DWORD dst_unused:UNUSED_PAD src0_sel:DWORD src1_sel:WORD_0
    v_lshlrev_b32_sdwa v11, 2, v8 dst_sel:DWORD dst_unused:UNUSED_PAD src0_sel:DWORD src1_sel:WORD_1
    v_mul_u32_u24_sdwa v12, s87, v10 dst_sel:DWORD dst_unused:UNUSED_PAD src0_sel:DWORD src1_sel:WORD_1
    v_mul_u32_u24_sdwa v10, 10, v10 dst_sel:DWORD dst_unused:UNUSED_PAD src0_sel:DWORD src1_sel:WORD_1
    v_add_u32 v12, v12, v11
    v_lshlrev_b32_sdwa v10, v10, v73 dst_sel:DWORD dst_unused:UNUSED_PAD src0_sel:DWORD src1_sel:WORD_1
    ds_write_b32 v12, v49 offset:47136
    ds_or_b32 v11, v10 offset:10272
    v_and_b32 v8, 0xffff, v78
    ds_add_rtn_u32 v8, v8, v4 offset:0
    s_waitcnt lgkmcnt(12)
    v_mul_u32_u24_sdwa v13, 3, v9 dst_sel:DWORD dst_unused:UNUSED_PAD src0_sel:DWORD src1_sel:WORD_0
    v_lshlrev_b32_sdwa v14, 2, v9 dst_sel:DWORD dst_unused:UNUSED_PAD src0_sel:DWORD src1_sel:WORD_1
    v_mul_u32_u24_sdwa v15, s87, v13 dst_sel:DWORD dst_unused:UNUSED_PAD src0_sel:DWORD src1_sel:WORD_1
    v_mul_u32_u24_sdwa v13, 10, v13 dst_sel:DWORD dst_unused:UNUSED_PAD src0_sel:DWORD src1_sel:WORD_1
    v_add_u32 v15, v15, v14
    v_lshlrev_b32_sdwa v13, v13, v74 dst_sel:DWORD dst_unused:UNUSED_PAD src0_sel:DWORD src1_sel:WORD_1
    ds_write_b32 v15, v50 offset:47136
    ds_or_b32 v14, v13 offset:10272
    s_mov_b32 s38, 25170944
    buffer_load_dwordx4 v[124:127], v1, s[12:15], s38 offen nt
    buffer_load_dwordx4 v[100:103], v1, s[8:11], s38 offen nt
    s_add_u32 s38, s86, 1792
    v_lshlrev_b32 v30, 2, v0
    v_cndmask_b32 v30, -16, v30, s[92:93]
    buffer_load_dword v31, v30, s[12:15], s38 offen nt
    buffer_load_dword v30, v30, s[8:11], s38 offen nt
    v_and_b32 v9, 0xffff, v79
    ds_add_rtn_u32 v9, v9, v4 offset:0
    s_waitcnt lgkmcnt(12)
    v_mul_u32_u24_sdwa v10, 3, v5 dst_sel:DWORD dst_unused:UNUSED_PAD src0_sel:DWORD src1_sel:WORD_0
    v_lshlrev_b32_sdwa v11, 2, v5 dst_sel:DWORD dst_unused:UNUSED_PAD src0_sel:DWORD src1_sel:WORD_1
    v_mul_u32_u24_sdwa v12, s87, v10 dst_sel:DWORD dst_unused:UNUSED_PAD src0_sel:DWORD src1_sel:WORD_1
    v_mul_u32_u24_sdwa v10, 10, v10 dst_sel:DWORD dst_unused:UNUSED_PAD src0_sel:DWORD src1_sel:WORD_1
    v_add_u32 v12, v12, v11
    v_lshlrev_b32_sdwa v10, v10, v75 dst_sel:DWORD dst_unused:UNUSED_PAD src0_sel:DWORD src1_sel:WORD_1
    ds_write_b32 v12, v51 offset:47136
    ds_or_b32 v11, v10 offset:10272
    s_waitcnt vmcnt(9)
    v_mul_hi_u32_u24 v20, s32, v112
    v_mul_hi_u32_u24 v21, s32, v113
    v_mul_hi_u32_u24 v22, s32, v114
    v_mul_hi_u32_u24 v23, s32, v115
    v_mad_i32_i24 v112, v20, s33, v112
    v_mad_i32_i24 v113, v21, s33, v113
    v_mad_i32_i24 v114, v22, s33, v114
    v_mad_i32_i24 v115, v23, s33, v115
    s_waitcnt vmcnt(8)
    v_lshrrev_b32 v24, 4, v88
    v_lshrrev_b32 v25, 4, v89
    v_lshrrev_b32 v26, 4, v90
    v_lshrrev_b32 v27, 4, v91
    v_mul_hi_u32_u24 v24, s34, v24
    v_mul_hi_u32_u24 v25, s34, v25
    v_mul_hi_u32_u24 v26, s34, v26
    v_mul_hi_u32_u24 v27, s34, v27
    v_mad_i32_i24 v88, v24, s35, v88
    v_lshl_add_u32 v20, v24, 6, v20
    v_mad_i32_i24 v89, v25, s35, v89
    v_lshl_add_u32 v21, v25, 6, v21
    v_mad_i32_i24 v90, v26, s35, v90
    v_lshl_add_u32 v22, v26, 6, v22
    v_mad_i32_i24 v91, v27, s35, v91
    v_lshl_add_u32 v23, v27, 6, v23
    v_mul_u32_u24 v24, 43691, v88
    v_lshl_add_u32 v88, v112, 7, v88
    v_lshlrev_b32 v20, 2, v20
    v_mul_u32_u24 v25, 43691, v89
    v_lshl_add_u32 v89, v113, 7, v89
    v_lshlrev_b32 v21, 2, v21
    v_mul_u32_u24 v26, 43691, v90
    v_lshl_add_u32 v90, v114, 7, v90
    v_lshlrev_b32 v22, 2, v22
    v_mul_u32_u24 v27, 43691, v91
    v_lshl_add_u32 v91, v115, 7, v91
    v_lshlrev_b32 v23, 2, v23
    ds_add_u32 v20, v3 offset:5120
    ds_add_u32 v21, v3 offset:5120
    ds_add_u32 v22, v3 offset:5120
    ds_add_u32 v23, v3 offset:5120
    v_lshrrev_b32 v24, 22, v24
    v_lshl_or_b32 v112, v20, 25, v20
    v_lshrrev_b32 v25, 22, v25
    v_lshl_or_b32 v113, v21, 25, v21
    v_lshrrev_b32 v26, 22, v26
    v_lshl_or_b32 v114, v22, 25, v22
    v_lshrrev_b32 v27, 22, v27
    v_lshl_or_b32 v115, v23, 25, v23
    v_and_or_b32 v112, v112, s37, v17
    v_and_or_b32 v113, v113, s37, v17
    v_and_or_b32 v114, v114, s37, v17
    v_and_or_b32 v115, v115, s37, v17
    v_mad_i32_i24 v88, v24, s96, v88
    v_lshl_add_u32 v112, v24, 18, v112
    v_mad_i32_i24 v89, v25, s96, v89
    v_lshl_add_u32 v113, v25, 18, v113
    v_mad_i32_i24 v90, v26, s96, v90
    v_lshl_add_u32 v114, v26, 18, v114
    v_mad_i32_i24 v91, v27, s96, v91
    v_lshl_add_u32 v115, v27, 18, v115
    s_waitcnt lgkmcnt(15)
    v_mul_u32_u24_sdwa v13, 3, v6 dst_sel:DWORD dst_unused:UNUSED_PAD src0_sel:DWORD src1_sel:WORD_0
    v_lshlrev_b32_sdwa v14, 2, v6 dst_sel:DWORD dst_unused:UNUSED_PAD src0_sel:DWORD src1_sel:WORD_1
    v_mul_u32_u24_sdwa v15, s87, v13 dst_sel:DWORD dst_unused:UNUSED_PAD src0_sel:DWORD src1_sel:WORD_1
    v_mul_u32_u24_sdwa v13, 10, v13 dst_sel:DWORD dst_unused:UNUSED_PAD src0_sel:DWORD src1_sel:WORD_1
    v_add_u32 v15, v15, v14
    v_lshlrev_b32_sdwa v13, v13, v76 dst_sel:DWORD dst_unused:UNUSED_PAD src0_sel:DWORD src1_sel:WORD_1
    ds_write_b32 v15, v52 offset:47136
    ds_or_b32 v14, v13 offset:10272
    s_waitcnt lgkmcnt(14)
    v_mul_u32_u24_sdwa v10, 3, v7 dst_sel:DWORD dst_unused:UNUSED_PAD src0_sel:DWORD src1_sel:WORD_0
    v_lshlrev_b32_sdwa v11, 2, v7 dst_sel:DWORD dst_unused:UNUSED_PAD src0_sel:DWORD src1_sel:WORD_1
    v_mul_u32_u24_sdwa v12, s87, v10 dst_sel:DWORD dst_unused:UNUSED_PAD src0_sel:DWORD src1_sel:WORD_1
    v_mul_u32_u24_sdwa v10, 10, v10 dst_sel:DWORD dst_unused:UNUSED_PAD src0_sel:DWORD src1_sel:WORD_1
    v_add_u32 v12, v12, v11
    v_lshlrev_b32_sdwa v10, v10, v77 dst_sel:DWORD dst_unused:UNUSED_PAD src0_sel:DWORD src1_sel:WORD_1
    ds_write_b32 v12, v53 offset:47136
    ds_or_b32 v11, v10 offset:10272
    s_waitcnt lgkmcnt(13)
    v_mul_u32_u24_sdwa v13, 3, v8 dst_sel:DWORD dst_unused:UNUSED_PAD src0_sel:DWORD src1_sel:WORD_0
    v_lshlrev_b32_sdwa v14, 2, v8 dst_sel:DWORD dst_unused:UNUSED_PAD src0_sel:DWORD src1_sel:WORD_1
    v_mul_u32_u24_sdwa v15, s87, v13 dst_sel:DWORD dst_unused:UNUSED_PAD src0_sel:DWORD src1_sel:WORD_1
    v_mul_u32_u24_sdwa v13, 10, v13 dst_sel:DWORD dst_unused:UNUSED_PAD src0_sel:DWORD src1_sel:WORD_1
    v_add_u32 v15, v15, v14
    v_lshlrev_b32_sdwa v13, v13, v78 dst_sel:DWORD dst_unused:UNUSED_PAD src0_sel:DWORD src1_sel:WORD_1
    ds_write_b32 v15, v54 offset:47136
    ds_or_b32 v14, v13 offset:10272
    s_waitcnt lgkmcnt(12)
    v_mul_u32_u24_sdwa v10, 3, v9 dst_sel:DWORD dst_unused:UNUSED_PAD src0_sel:DWORD src1_sel:WORD_0
    v_lshlrev_b32_sdwa v11, 2, v9 dst_sel:DWORD dst_unused:UNUSED_PAD src0_sel:DWORD src1_sel:WORD_1
    v_mul_u32_u24_sdwa v12, s87, v10 dst_sel:DWORD dst_unused:UNUSED_PAD src0_sel:DWORD src1_sel:WORD_1
    v_mul_u32_u24_sdwa v10, 10, v10 dst_sel:DWORD dst_unused:UNUSED_PAD src0_sel:DWORD src1_sel:WORD_1
    v_add_u32 v12, v12, v11
    v_lshlrev_b32_sdwa v10, v10, v79 dst_sel:DWORD dst_unused:UNUSED_PAD src0_sel:DWORD src1_sel:WORD_1
    ds_write_b32 v12, v55 offset:47136
    ds_or_b32 v11, v10 offset:10272
    s_waitcnt lgkmcnt(0)
    s_barrier
    v_mov_b32 v9, 0
    ds_read_b128 v[10:13], v9 offset:10240
    v_lshlrev_b32 v5, 2, v0
    v_add_u32 v5, 10272, v5
    v_add_u32 v6, 73728, v5
    v_add_u32 v7, 20480, v5
    v_add_u32 v8, 20480, v6
    ds_read2st64_b32 v[32:33], v5 offset0:0 offset1:144
    ds_read2st64_b32 v[34:35], v6 offset0:0 offset1:144
    ds_read2st64_b32 v[36:37], v5 offset0:16 offset1:160
    ds_read2st64_b32 v[38:39], v6 offset0:16 offset1:160
    ds_read2st64_b32 v[40:41], v5 offset0:32 offset1:176
    ds_read2st64_b32 v[42:43], v6 offset0:32 offset1:176
    ds_read2st64_b32 v[44:45], v5 offset0:48 offset1:192
    ds_read2st64_b32 v[46:47], v6 offset0:48 offset1:192
    s_waitcnt lgkmcnt(8)
    v_add3_u32 v10, v10, v11, v12
    v_add3_u32 v10, v10, v13, 23
    v_mul_u32_u24 v10, v4, v10
    v_lshrrev_b32 v10, 16, v10
    v_and_b32 v10, -8, v10
    v_subrev_u32 v10, 8192, v10
    v_cmp_lt_u32 s[88:89], v0, v10
    ds_read2st64_b32 v[48:49], v5 offset0:64 offset1:208
    ds_read2st64_b32 v[50:51], v6 offset0:64 offset1:208
    ds_read2st64_b32 v[52:53], v7 offset0:0 offset1:144
    ds_read2st64_b32 v[54:55], v8 offset0:0 offset1:144
    ds_read2st64_b32 v[56:57], v7 offset0:16 offset1:160
    ds_read2st64_b32 v[58:59], v8 offset0:16 offset1:160
    ds_read2st64_b32 v[60:61], v7 offset0:32 offset1:176
    ds_read2st64_b32 v[62:63], v8 offset0:32 offset1:176
    ds_read2st64_b32 v[64:65], v7 offset0:48 offset1:192
    ds_read2st64_b32 v[66:67], v8 offset0:48 offset1:192
    s_mov_b32 s38, 12582912
    buffer_load_dwordx2 v[20:21], v2, s[16:19], s38 offen nt
    s_mov_b32 s38, 12583424
    buffer_load_dwordx2 v[22:23], v2, s[16:19], s38 offen nt
    s_mov_b32 s38, 12583936
    buffer_load_dwordx2 v[24:25], v2, s[16:19], s38 offen nt
    s_mov_b32 s38, 12584448
    buffer_load_dwordx2 v[26:27], v2, s[16:19], s38 offen nt
    s_add_u32 s38, s86, 1792
    s_lshr_b32 s38, s38, 1
    v_lshlrev_b32 v78, 1, v0
    v_cndmask_b32 v78, -16, v78, s[92:93]
    buffer_load_ushort v78, v78, s[16:19], s38 offen nt
    s_mov_b32 s38, 12584960
    buffer_load_dwordx2 v[72:73], v2, s[16:19], s38 offen nt
    s_mov_b32 s38, 12585472
    buffer_load_dwordx2 v[74:75], v2, s[16:19], s38 offen nt
    s_waitcnt vmcnt(14)
    v_mul_hi_u32_u24 v5, s32, v116
    v_mul_hi_u32_u24 v6, s32, v117
    v_mul_hi_u32_u24 v7, s32, v118
    v_mul_hi_u32_u24 v8, s32, v119
    v_mad_i32_i24 v116, v5, s33, v116
    v_mad_i32_i24 v117, v6, s33, v117
    v_mad_i32_i24 v118, v7, s33, v118
    v_mad_i32_i24 v119, v8, s33, v119
    s_waitcnt vmcnt(13)
    v_lshrrev_b32 v9, 4, v92
    v_lshrrev_b32 v10, 4, v93
    v_lshrrev_b32 v11, 4, v94
    v_lshrrev_b32 v12, 4, v95
    v_mul_hi_u32_u24 v9, s34, v9
    v_mul_hi_u32_u24 v10, s34, v10
    v_mul_hi_u32_u24 v11, s34, v11
    v_mul_hi_u32_u24 v12, s34, v12
    v_mad_i32_i24 v92, v9, s35, v92
    v_lshl_add_u32 v5, v9, 6, v5
    v_mad_i32_i24 v93, v10, s35, v93
    v_lshl_add_u32 v6, v10, 6, v6
    v_mad_i32_i24 v94, v11, s35, v94
    v_lshl_add_u32 v7, v11, 6, v7
    v_mad_i32_i24 v95, v12, s35, v95
    v_lshl_add_u32 v8, v12, 6, v8
    v_mul_u32_u24 v9, 43691, v92
    v_lshl_add_u32 v92, v116, 7, v92
    v_lshlrev_b32 v5, 2, v5
    v_mul_u32_u24 v10, 43691, v93
    v_lshl_add_u32 v93, v117, 7, v93
    v_lshlrev_b32 v6, 2, v6
    v_mul_u32_u24 v11, 43691, v94
    v_lshl_add_u32 v94, v118, 7, v94
    v_lshlrev_b32 v7, 2, v7
    v_mul_u32_u24 v12, 43691, v95
    v_lshl_add_u32 v95, v119, 7, v95
    v_lshlrev_b32 v8, 2, v8
    ds_add_u32 v5, v3 offset:5120
    ds_add_u32 v6, v3 offset:5120
    ds_add_u32 v7, v3 offset:5120
    ds_add_u32 v8, v3 offset:5120
    v_lshrrev_b32 v9, 22, v9
    v_lshl_or_b32 v116, v5, 25, v5
    v_lshrrev_b32 v10, 22, v10
    v_lshl_or_b32 v117, v6, 25, v6
    v_lshrrev_b32 v11, 22, v11
    v_lshl_or_b32 v118, v7, 25, v7
    v_lshrrev_b32 v12, 22, v12
    v_lshl_or_b32 v119, v8, 25, v8
    v_and_or_b32 v116, v116, s37, v17
    v_and_or_b32 v117, v117, s37, v17
    v_and_or_b32 v118, v118, s37, v17
    v_and_or_b32 v119, v119, s37, v17
    v_mad_i32_i24 v92, v9, s96, v92
    v_lshl_add_u32 v116, v9, 18, v116
    v_mad_i32_i24 v93, v10, s96, v93
    v_lshl_add_u32 v117, v10, 18, v117
    v_mad_i32_i24 v94, v11, s96, v94
    v_lshl_add_u32 v118, v11, 18, v118
    v_mad_i32_i24 v95, v12, s96, v95
    v_lshl_add_u32 v119, v12, 18, v119
    s_waitcnt lgkmcnt(0)
    s_waitcnt vmcnt(12)
    v_mul_hi_u32_u24 v5, s32, v120
    v_mul_hi_u32_u24 v6, s32, v121
    v_mul_hi_u32_u24 v7, s32, v122
    v_mul_hi_u32_u24 v8, s32, v123
    v_mad_i32_i24 v120, v5, s33, v120
    v_mad_i32_i24 v121, v6, s33, v121
    v_mad_i32_i24 v122, v7, s33, v122
    v_mad_i32_i24 v123, v8, s33, v123
    s_waitcnt vmcnt(11)
    v_lshrrev_b32 v9, 4, v96
    v_lshrrev_b32 v10, 4, v97
    v_lshrrev_b32 v11, 4, v98
    v_lshrrev_b32 v12, 4, v99
    v_mul_hi_u32_u24 v9, s34, v9
    v_mul_hi_u32_u24 v10, s34, v10
    v_mul_hi_u32_u24 v11, s34, v11
    v_mul_hi_u32_u24 v12, s34, v12
    v_mad_i32_i24 v96, v9, s35, v96
    v_lshl_add_u32 v5, v9, 6, v5
    v_mad_i32_i24 v97, v10, s35, v97
    v_lshl_add_u32 v6, v10, 6, v6
    v_mad_i32_i24 v98, v11, s35, v98
    v_lshl_add_u32 v7, v11, 6, v7
    v_mad_i32_i24 v99, v12, s35, v99
    v_lshl_add_u32 v8, v12, 6, v8
    v_mul_u32_u24 v9, 43691, v96
    v_lshl_add_u32 v96, v120, 7, v96
    v_lshlrev_b32 v5, 2, v5
    v_mul_u32_u24 v10, 43691, v97
    v_lshl_add_u32 v97, v121, 7, v97
    v_lshlrev_b32 v6, 2, v6
    v_mul_u32_u24 v11, 43691, v98
    v_lshl_add_u32 v98, v122, 7, v98
    v_lshlrev_b32 v7, 2, v7
    v_mul_u32_u24 v12, 43691, v99
    v_lshl_add_u32 v99, v123, 7, v99
    v_lshlrev_b32 v8, 2, v8
    ds_add_u32 v5, v3 offset:5120
    ds_add_u32 v6, v3 offset:5120
    ds_add_u32 v7, v3 offset:5120
    ds_add_u32 v8, v3 offset:5120
    v_lshrrev_b32 v9, 22, v9
    v_lshl_or_b32 v120, v5, 25, v5
    v_lshrrev_b32 v10, 22, v10
    v_lshl_or_b32 v121, v6, 25, v6
    v_lshrrev_b32 v11, 22, v11
    v_lshl_or_b32 v122, v7, 25, v7
    v_lshrrev_b32 v12, 22, v12
    v_lshl_or_b32 v123, v8, 25, v8
    v_and_or_b32 v120, v120, s37, v17
    v_and_or_b32 v121, v121, s37, v17
    v_and_or_b32 v122, v122, s37, v17
    v_and_or_b32 v123, v123, s37, v17
    v_mad_i32_i24 v96, v9, s96, v96
    v_lshl_add_u32 v120, v9, 18, v120
    v_mad_i32_i24 v97, v10, s96, v97
    v_lshl_add_u32 v121, v10, 18, v121
    v_mad_i32_i24 v98, v11, s96, v98
    v_lshl_add_u32 v122, v11, 18, v122
    v_mad_i32_i24 v99, v12, s96, v99
    v_lshl_add_u32 v123, v12, 18, v123
    s_waitcnt vmcnt(10)
    v_mul_hi_u32_u24 v5, s32, v124
    v_mul_hi_u32_u24 v6, s32, v125
    v_mul_hi_u32_u24 v7, s32, v126
    v_mul_hi_u32_u24 v8, s32, v127
    v_mad_i32_i24 v124, v5, s33, v124
    v_mad_i32_i24 v125, v6, s33, v125
    v_mad_i32_i24 v126, v7, s33, v126
    v_mad_i32_i24 v127, v8, s33, v127
    s_waitcnt vmcnt(9)
    v_lshrrev_b32 v9, 4, v100
    v_lshrrev_b32 v10, 4, v101
    v_lshrrev_b32 v11, 4, v102
    v_lshrrev_b32 v12, 4, v103
    v_mul_hi_u32_u24 v9, s34, v9
    v_mul_hi_u32_u24 v10, s34, v10
    v_mul_hi_u32_u24 v11, s34, v11
    v_mul_hi_u32_u24 v12, s34, v12
    v_mad_i32_i24 v100, v9, s35, v100
    v_lshl_add_u32 v5, v9, 6, v5
    v_mad_i32_i24 v101, v10, s35, v101
    v_lshl_add_u32 v6, v10, 6, v6
    v_mad_i32_i24 v102, v11, s35, v102
    v_lshl_add_u32 v7, v11, 6, v7
    v_mad_i32_i24 v103, v12, s35, v103
    v_lshl_add_u32 v8, v12, 6, v8
    v_mul_u32_u24 v9, 43691, v100
    v_lshl_add_u32 v100, v124, 7, v100
    v_lshlrev_b32 v5, 2, v5
    v_mul_u32_u24 v10, 43691, v101
    v_lshl_add_u32 v101, v125, 7, v101
    v_lshlrev_b32 v6, 2, v6
    v_mul_u32_u24 v11, 43691, v102
    v_lshl_add_u32 v102, v126, 7, v102
    v_lshlrev_b32 v7, 2, v7
    v_mul_u32_u24 v12, 43691, v103
    v_lshl_add_u32 v103, v127, 7, v103
    v_lshlrev_b32 v8, 2, v8
    ds_add_u32 v5, v3 offset:5120
    ds_add_u32 v6, v3 offset:5120
    ds_add_u32 v7, v3 offset:5120
    ds_add_u32 v8, v3 offset:5120
    v_lshrrev_b32 v9, 22, v9
    v_lshl_or_b32 v124, v5, 25, v5
    v_lshrrev_b32 v10, 22, v10
    v_lshl_or_b32 v125, v6, 25, v6
    v_lshrrev_b32 v11, 22, v11
    v_lshl_or_b32 v126, v7, 25, v7
    v_lshrrev_b32 v12, 22, v12
    v_lshl_or_b32 v127, v8, 25, v8
    v_and_or_b32 v124, v124, s37, v17
    v_and_or_b32 v125, v125, s37, v17
    v_and_or_b32 v126, v126, s37, v17
    v_and_or_b32 v127, v127, s37, v17
    v_mad_i32_i24 v100, v9, s96, v100
    v_lshl_add_u32 v124, v9, 18, v124
    v_mad_i32_i24 v101, v10, s96, v101
    v_lshl_add_u32 v125, v10, 18, v125
    v_mad_i32_i24 v102, v11, s96, v102
    v_lshl_add_u32 v126, v11, 18, v126
    v_mad_i32_i24 v103, v12, s96, v103
    v_lshl_add_u32 v127, v12, 18, v127
    s_waitcnt vmcnt(8)
    v_mul_hi_u32_u24 v5, s32, v31
    v_mad_i32_i24 v31, v5, s33, v31
    s_waitcnt vmcnt(7)
    v_lshrrev_b32 v9, 4, v30
    v_mul_hi_u32_u24 v9, s34, v9
    v_mad_i32_i24 v30, v9, s35, v30
    v_lshl_add_u32 v5, v9, 6, v5
    v_mul_u32_u24 v9, 43691, v30
    v_lshl_add_u32 v30, v31, 7, v30
    v_lshlrev_b32 v5, 2, v5
    s_mov_b64 exec, s[92:93]
    ds_add_u32 v5, v3 offset:5120
    s_mov_b64 exec, -1
    v_lshrrev_b32 v9, 22, v9
    v_lshl_or_b32 v31, v5, 25, v5
    v_and_or_b32 v31, v31, s37, v17
    v_mad_i32_i24 v30, v9, s96, v30
    v_lshl_add_u32 v31, v9, 18, v31
    s_waitcnt lgkmcnt(0)
    s_barrier
    s_cmp_lt_u32 s39, 4
    s_cbranch_scc1 L_p1_kernel_scan1_s
    v_mov_b32 v6, 0
    v_mov_b32 v7, 0
    v_mov_b32 v8, 0
    v_mov_b32 v9, 0
    ds_write_b128 v1, v[6:9] offset:6176
    ds_write_b128 v1, v[6:9] offset:18464
    ds_write_b128 v1, v[6:9] offset:30752
    ds_read_b32 v5, v6 offset:10256
    v_mov_b32 v10, s2
    s_waitcnt lgkmcnt(0)
    v_lshrrev_b32 v5, 7, v5
    s_cmp_lg_u32 s39, 4
    s_cbranch_scc1 L_p1_kernel_scan1_a
    s_mov_b64 exec, 1
    global_store_byte v10, v5, s[84:85]
    s_mov_b64 exec, 15
    v_lshl_add_u32 v10, v10, 2, v0
    v_lshlrev_b32 v10, 7, v10
    v_add_u32 v10, 4294937600, v10
    global_store_dword v10, v6, s[84:85]
    s_mov_b64 exec, -1
    s_waitcnt lgkmcnt(0)
    s_branch L_p1_kernel_scan1_a
L_p1_kernel_scan1_s:
    s_mul_i32 s38, s39, 1024
    v_lshl_add_u32 v5, v0, 2, s38
    ds_read_b32 v6, v5 offset:5120
    ds_read_b32 v7, v5 offset:5376
    ds_read_b32 v8, v5 offset:5632
    ds_read_b32 v9, v5 offset:5888
    ds_read_b32 v10, v5 offset:6144
    s_waitcnt lgkmcnt(0)
    v_max_u32 v6, 2, v6
    v_max_u32 v7, 2, v7
    v_max_u32 v8, 2, v8
    v_max_u32 v9, 2, v9
    v_max_u32 v10, 2, v10
    v_add_u32_dpp v12, v6, v6 row_shr:1 row_mask:0xf bank_mask:0xf bound_ctrl:0
    v_add_u32_dpp v13, v7, v7 row_shr:1 row_mask:0xf bank_mask:0xf bound_ctrl:0
    v_add_u32_dpp v14, v8, v8 row_shr:1 row_mask:0xf bank_mask:0xf bound_ctrl:0
    v_add_u32_dpp v15, v9, v9 row_shr:1 row_mask:0xf bank_mask:0xf bound_ctrl:0
    v_add_u32_dpp v16, v10, v10 row_shr:1 row_mask:0xf bank_mask:0xf bound_ctrl:0
    v_add_u32_dpp v12, v12, v12 row_shr:2 row_mask:0xf bank_mask:0xf bound_ctrl:0
    v_add_u32_dpp v13, v13, v13 row_shr:2 row_mask:0xf bank_mask:0xf bound_ctrl:0
    v_add_u32_dpp v14, v14, v14 row_shr:2 row_mask:0xf bank_mask:0xf bound_ctrl:0
    v_add_u32_dpp v15, v15, v15 row_shr:2 row_mask:0xf bank_mask:0xf bound_ctrl:0
    v_add_u32_dpp v16, v16, v16 row_shr:2 row_mask:0xf bank_mask:0xf bound_ctrl:0
    v_add_u32_dpp v12, v12, v12 row_shr:4 row_mask:0xf bank_mask:0xf bound_ctrl:0
    v_add_u32_dpp v13, v13, v13 row_shr:4 row_mask:0xf bank_mask:0xf bound_ctrl:0
    v_add_u32_dpp v14, v14, v14 row_shr:4 row_mask:0xf bank_mask:0xf bound_ctrl:0
    v_add_u32_dpp v15, v15, v15 row_shr:4 row_mask:0xf bank_mask:0xf bound_ctrl:0
    v_add_u32_dpp v16, v16, v16 row_shr:4 row_mask:0xf bank_mask:0xf bound_ctrl:0
    v_add_u32_dpp v12, v12, v12 row_shr:8 row_mask:0xf bank_mask:0xf bound_ctrl:0
    v_add_u32_dpp v13, v13, v13 row_shr:8 row_mask:0xf bank_mask:0xf bound_ctrl:0
    v_add_u32_dpp v14, v14, v14 row_shr:8 row_mask:0xf bank_mask:0xf bound_ctrl:0
    v_add_u32_dpp v15, v15, v15 row_shr:8 row_mask:0xf bank_mask:0xf bound_ctrl:0
    v_add_u32_dpp v16, v16, v16 row_shr:8 row_mask:0xf bank_mask:0xf bound_ctrl:0
    v_add_u32_dpp v12, v12, v12 row_bcast:15 row_mask:0xa bank_mask:0xf
    v_add_u32_dpp v13, v13, v13 row_bcast:15 row_mask:0xa bank_mask:0xf
    v_add_u32_dpp v14, v14, v14 row_bcast:15 row_mask:0xa bank_mask:0xf
    v_add_u32_dpp v15, v15, v15 row_bcast:15 row_mask:0xa bank_mask:0xf
    v_add_u32_dpp v16, v16, v16 row_bcast:15 row_mask:0xa bank_mask:0xf
    v_add_u32_dpp v12, v12, v12 row_bcast:31 row_mask:0xc bank_mask:0xf
    v_add_u32_dpp v13, v13, v13 row_bcast:31 row_mask:0xc bank_mask:0xf
    v_add_u32_dpp v14, v14, v14 row_bcast:31 row_mask:0xc bank_mask:0xf
    v_add_u32_dpp v15, v15, v15 row_bcast:31 row_mask:0xc bank_mask:0xf
    v_add_u32_dpp v16, v16, v16 row_bcast:31 row_mask:0xc bank_mask:0xf
    v_readlane_b32 s4, v12, 63
    v_readlane_b32 s5, v13, 63
    v_readlane_b32 s6, v14, 63
    v_readlane_b32 s7, v15, 63
    v_readlane_b32 s42, v16, 63
    v_sub_u32 v12, v12, v6
    v_sub_u32 v13, v13, v7
    v_sub_u32 v14, v14, v8
    v_sub_u32 v15, v15, v9
    v_sub_u32 v16, v16, v10
    s_add_u32 s5, s5, s4
    s_add_u32 s6, s6, s5
    s_add_u32 s7, s7, s6
    s_add_u32 s42, s42, s7
    v_add_u32 v13, s4, v13
    v_add_u32 v14, s5, v14
    v_add_u32 v15, s6, v15
    v_add_u32 v16, s7, v16
    s_lshl_b32 s38, s39, 2
    v_mov_b32 v18, s42
    v_mov_b32 v19, s38
    ds_write_b32 v19, v18 offset:10240
    s_waitcnt lgkmcnt(0)
L_p1_kernel_scan1_a:
    s_barrier
    s_cmp_ge_u32 s39, 4
    s_cbranch_scc1 L_p1_kernel_scan1_b
    v_and_b32 v19, 3, v0
    v_cmp_gt_u32 vcc, s39, v19
    v_lshlrev_b32 v18, 2, v19
    ds_read_b32 v18, v18 offset:10240
    s_waitcnt lgkmcnt(0)
    v_cndmask_b32 v18, 0, v18, vcc
    s_nop 1
    v_add_u32_dpp v18, v18, v18 quad_perm:[1,0,3,2] row_mask:0xf bank_mask:0xf
    s_nop 1
    v_add_u32_dpp v18, v18, v18 quad_perm:[2,3,0,1] row_mask:0xf bank_mask:0xf
    v_add_u32 v12, v18, v12
    v_add_u32 v13, v18, v13
    v_add_u32 v14, v18, v14
    v_add_u32 v15, v18, v15
    v_add_u32 v16, v18, v16
    v_add3_u32 v6, v12, v6, 2
    v_mul_u32_u24 v12, v4, v12
    v_mul_u32_u24 v6, v4, v6
    v_lshrrev_b32 v18, 16, v12
    v_sub_u32_sdwa v6, v6, v18 dst_sel:DWORD dst_unused:UNUSED_PAD src0_sel:WORD_1 src1_sel:DWORD
    v_lshl_or_b32 v6, v6, 16, v18
    v_add3_u32 v7, v13, v7, 2
    v_mul_u32_u24 v13, v4, v13
    v_mul_u32_u24 v7, v4, v7
    v_lshrrev_b32 v18, 16, v13
    v_sub_u32_sdwa v7, v7, v18 dst_sel:DWORD dst_unused:UNUSED_PAD src0_sel:WORD_1 src1_sel:DWORD
    v_lshl_or_b32 v7, v7, 16, v18
    v_add3_u32 v8, v14, v8, 2
    v_mul_u32_u24 v14, v4, v14
    v_mul_u32_u24 v8, v4, v8
    v_lshrrev_b32 v18, 16, v14
    v_sub_u32_sdwa v8, v8, v18 dst_sel:DWORD dst_unused:UNUSED_PAD src0_sel:WORD_1 src1_sel:DWORD
    v_lshl_or_b32 v8, v8, 16, v18
    v_add3_u32 v9, v15, v9, 2
    v_mul_u32_u24 v15, v4, v15
    v_mul_u32_u24 v9, v4, v9
    v_lshrrev_b32 v18, 16, v15
    v_sub_u32_sdwa v9, v9, v18 dst_sel:DWORD dst_unused:UNUSED_PAD src0_sel:WORD_1 src1_sel:DWORD
    v_lshl_or_b32 v9, v9, 16, v18
    v_add3_u32 v10, v16, v10, 2
    v_mul_u32_u24 v16, v4, v16
    v_mul_u32_u24 v10, v4, v10
    v_lshrrev_b32 v18, 16, v16
    v_sub_u32_sdwa v10, v10, v18 dst_sel:DWORD dst_unused:UNUSED_PAD src0_sel:WORD_1 src1_sel:DWORD
    v_lshl_or_b32 v10, v10, 16, v18
    ds_write_b32 v5, v12 offset:5120
    ds_write_b32 v5, v13 offset:5376
    ds_write_b32 v5, v14 offset:5632
    ds_write_b32 v5, v15 offset:5888
    ds_write_b32 v5, v16 offset:6144
    v_mul_u32_u24 v18, 40, v0
    s_mov_b32 s38, 20
    buffer_store_dwordx4 v[6:9], v18, s[28:31], s38 offen
    buffer_store_dword v10, v18, s[28:31], s38 offen offset:16
    s_waitcnt lgkmcnt(0)
L_p1_kernel_scan1_b:
    s_barrier
    v_and_b32 v5, 0xffff, v31
    s_mov_b64 exec, s[92:93]
    ds_add_rtn_u32 v5, v5, v4 offset:5120
    s_mov_b64 exec, -1
    v_and_b32 v6, 0xffff, v104
    ds_add_rtn_u32 v6, v6, v4 offset:5120
    v_and_b32 v7, 0xffff, v105
    ds_add_rtn_u32 v7, v7, v4 offset:5120
    v_and_b32 v8, 0xffff, v106
    ds_add_rtn_u32 v8, v8, v4 offset:5120
    v_and_b32 v9, 0xffff, v107
    ds_add_rtn_u32 v9, v9, v4 offset:5120
    s_waitcnt vmcnt(2)
    s_cmp_eq_u32 s36, 1.0
    s_cbranch_scc1 L_p1_kernel_f1_6
    v_lshlrev_b32 v68, 16, v78
    v_mul_f32 v68, s36, v68
    v_cvt_pk_bf16_f32 v78, v68, v68
L_p1_kernel_f1_6:
    v_lshlrev_b32 v68, 16, v78
    v_mul_f32 v68, 0.15915494, v68
    v_fract_f32 v68, v68
    v_cos_f32 v68, v68
    s_nop 0
    v_mul_f32 v68, 0x03800000, v68
    v_cvt_pk_bf16_f32 v76, v68, v68
    v_lshrrev_b32 v68, 5, v76
    v_bfi_b32 v76, s97, v68, v76
    v_lshl_or_b32 v30, v76, 21, v30
    s_waitcnt lgkmcnt(4)
    v_mul_u32_u24_sdwa v10, 3, v5 dst_sel:DWORD dst_unused:UNUSED_PAD src0_sel:DWORD src1_sel:WORD_0
    v_lshlrev_b32_sdwa v11, 2, v5 dst_sel:DWORD dst_unused:UNUSED_PAD src0_sel:DWORD src1_sel:WORD_1
    v_mul_u32_u24_sdwa v12, s87, v10 dst_sel:DWORD dst_unused:UNUSED_PAD src0_sel:DWORD src1_sel:WORD_1
    v_mul_u32_u24_sdwa v10, 10, v10 dst_sel:DWORD dst_unused:UNUSED_PAD src0_sel:DWORD src1_sel:WORD_1
    v_add_u32 v12, v12, v11
    v_lshlrev_b32_sdwa v10, v10, v31 dst_sel:DWORD dst_unused:UNUSED_PAD src0_sel:DWORD src1_sel:WORD_1
    s_mov_b64 exec, s[92:93]
    ds_write_b32 v12, v30 offset:47136
    ds_or_b32 v11, v10 offset:10272
    s_mov_b64 exec, -1
    s_mov_b32 s38, 0
    buffer_store_dwordx4 v[32:35], v1, s[20:23], s38 offen sc1
    v_and_b32 v5, 0xffff, v108
    ds_add_rtn_u32 v5, v5, v4 offset:5120
    s_cmp_eq_u32 s36, 1.0
    s_cbranch_scc1 L_p1_kernel_f1_0
    v_lshlrev_b32 v68, 16, v20
    v_and_b32 v69, 0xffff0000, v20
    v_lshlrev_b32 v70, 16, v21
    v_and_b32 v71, 0xffff0000, v21
    v_mul_f32 v68, s36, v68
    v_mul_f32 v69, s36, v69
    v_mul_f32 v70, s36, v70
    v_mul_f32 v71, s36, v71
    v_cvt_pk_bf16_f32 v20, v68, v69
    v_cvt_pk_bf16_f32 v21, v70, v71
L_p1_kernel_f1_0:
    v_lshlrev_b32 v68, 16, v20
    v_and_b32 v69, 0xffff0000, v20
    v_lshlrev_b32 v70, 16, v21
    v_and_b32 v71, 0xffff0000, v21
    v_mul_f32 v68, 0.15915494, v68
    v_mul_f32 v69, 0.15915494, v69
    v_mul_f32 v70, 0.15915494, v70
    v_mul_f32 v71, 0.15915494, v71
    v_fract_f32 v68, v68
    v_fract_f32 v69, v69
    v_fract_f32 v70, v70
    v_fract_f32 v71, v71
    v_cos_f32 v68, v68
    v_cos_f32 v69, v69
    v_cos_f32 v70, v70
    v_cos_f32 v71, v71
    v_mul_f32 v68, 0x03800000, v68
    v_mul_f32 v69, 0x03800000, v69
    v_mul_f32 v70, 0x03800000, v70
    v_mul_f32 v71, 0x03800000, v71
    v_cvt_pk_bf16_f32 v76, v68, v69
    v_cvt_pk_bf16_f32 v77, v70, v71
    v_lshrrev_b32 v68, 5, v76
    v_lshrrev_b32 v69, 5, v77
    v_bfi_b32 v76, s97, v68, v76
    v_bfi_b32 v77, s97, v69, v77
    v_lshl_or_b32 v80, v76, 21, v80
    v_lshlrev_b32 v68, 5, v76
    v_lshl_or_b32 v82, v77, 21, v82
    v_lshlrev_b32 v69, 5, v77
    v_and_or_b32 v81, v68, s95, v81
    v_and_or_b32 v83, v69, s95, v83
    s_waitcnt lgkmcnt(6)
    v_mul_u32_u24_sdwa v13, 3, v6 dst_sel:DWORD dst_unused:UNUSED_PAD src0_sel:DWORD src1_sel:WORD_0
    v_lshlrev_b32_sdwa v14, 2, v6 dst_sel:DWORD dst_unused:UNUSED_PAD src0_sel:DWORD src1_sel:WORD_1
    v_mul_u32_u24_sdwa v15, s87, v13 dst_sel:DWORD dst_unused:UNUSED_PAD src0_sel:DWORD src1_sel:WORD_1
    v_mul_u32_u24_sdwa v13, 10, v13 dst_sel:DWORD dst_unused:UNUSED_PAD src0_sel:DWORD src1_sel:WORD_1
    v_add_u32 v15, v15, v14
    v_lshlrev_b32_sdwa v13, v13, v104 dst_sel:DWORD dst_unused:UNUSED_PAD src0_sel:DWORD src1_sel:WORD_1
    ds_write_b32 v15, v80 offset:47136
    ds_or_b32 v14, v13 offset:10272
    v_and_b32 v6, 0xffff, v109
    ds_add_rtn_u32 v6, v6, v4 offset:5120
    s_waitcnt lgkmcnt(8)
    v_mul_u32_u24_sdwa v10, 3, v7 dst_sel:DWORD dst_unused:UNUSED_PAD src0_sel:DWORD src1_sel:WORD_0
    v_lshlrev_b32_sdwa v11, 2, v7 dst_sel:DWORD dst_unused:UNUSED_PAD src0_sel:DWORD src1_sel:WORD_1
    v_mul_u32_u24_sdwa v12, s87, v10 dst_sel:DWORD dst_unused:UNUSED_PAD src0_sel:DWORD src1_sel:WORD_1
    v_mul_u32_u24_sdwa v10, 10, v10 dst_sel:DWORD dst_unused:UNUSED_PAD src0_sel:DWORD src1_sel:WORD_1
    v_add_u32 v12, v12, v11
    v_lshlrev_b32_sdwa v10, v10, v105 dst_sel:DWORD dst_unused:UNUSED_PAD src0_sel:DWORD src1_sel:WORD_1
    ds_write_b32 v12, v81 offset:47136
    ds_or_b32 v11, v10 offset:10272
    s_mov_b32 s38, 16384
    buffer_store_dwordx4 v[36:39], v1, s[20:23], s38 offen sc1
    v_and_b32 v7, 0xffff, v110
    ds_add_rtn_u32 v7, v7, v4 offset:5120
    s_waitcnt lgkmcnt(10)
    v_mul_u32_u24_sdwa v13, 3, v8 dst_sel:DWORD dst_unused:UNUSED_PAD src0_sel:DWORD src1_sel:WORD_0
    v_lshlrev_b32_sdwa v14, 2, v8 dst_sel:DWORD dst_unused:UNUSED_PAD src0_sel:DWORD src1_sel:WORD_1
    v_mul_u32_u24_sdwa v15, s87, v13 dst_sel:DWORD dst_unused:UNUSED_PAD src0_sel:DWORD src1_sel:WORD_1
    v_mul_u32_u24_sdwa v13, 10, v13 dst_sel:DWORD dst_unused:UNUSED_PAD src0_sel:DWORD src1_sel:WORD_1
    v_add_u32 v15, v15, v14
    v_lshlrev_b32_sdwa v13, v13, v106 dst_sel:DWORD dst_unused:UNUSED_PAD src0_sel:DWORD src1_sel:WORD_1
    ds_write_b32 v15, v82 offset:47136
    ds_or_b32 v14, v13 offset:10272
    v_and_b32 v8, 0xffff, v111
    ds_add_rtn_u32 v8, v8, v4 offset:5120
    s_waitcnt lgkmcnt(12)
    v_mul_u32_u24_sdwa v10, 3, v9 dst_sel:DWORD dst_unused:UNUSED_PAD src0_sel:DWORD src1_sel:WORD_0
    v_lshlrev_b32_sdwa v11, 2, v9 dst_sel:DWORD dst_unused:UNUSED_PAD src0_sel:DWORD src1_sel:WORD_1
    v_mul_u32_u24_sdwa v12, s87, v10 dst_sel:DWORD dst_unused:UNUSED_PAD src0_sel:DWORD src1_sel:WORD_1
    v_mul_u32_u24_sdwa v10, 10, v10 dst_sel:DWORD dst_unused:UNUSED_PAD src0_sel:DWORD src1_sel:WORD_1
    v_add_u32 v12, v12, v11
    v_lshlrev_b32_sdwa v10, v10, v107 dst_sel:DWORD dst_unused:UNUSED_PAD src0_sel:DWORD src1_sel:WORD_1
    ds_write_b32 v12, v83 offset:47136
    ds_or_b32 v11, v10 offset:10272
    s_mov_b32 s38, 32768
    buffer_store_dwordx4 v[40:43], v1, s[20:23], s38 offen sc1
    v_and_b32 v9, 0xffff, v112
    ds_add_rtn_u32 v9, v9, v4 offset:5120
    s_cmp_eq_u32 s36, 1.0
    s_cbranch_scc1 L_p1_kernel_f1_1
    v_lshlrev_b32 v68, 16, v22
    v_and_b32 v69, 0xffff0000, v22
    v_lshlrev_b32 v70, 16, v23
    v_and_b32 v71, 0xffff0000, v23
    v_mul_f32 v68, s36, v68
    v_mul_f32 v69, s36, v69
    v_mul_f32 v70, s36, v70
    v_mul_f32 v71, s36, v71
    v_cvt_pk_bf16_f32 v22, v68, v69
    v_cvt_pk_bf16_f32 v23, v70, v71
L_p1_kernel_f1_1:
    v_lshlrev_b32 v68, 16, v22
    v_and_b32 v69, 0xffff0000, v22
    v_lshlrev_b32 v70, 16, v23
    v_and_b32 v71, 0xffff0000, v23
    v_mul_f32 v68, 0.15915494, v68
    v_mul_f32 v69, 0.15915494, v69
    v_mul_f32 v70, 0.15915494, v70
    v_mul_f32 v71, 0.15915494, v71
    v_fract_f32 v68, v68
    v_fract_f32 v69, v69
    v_fract_f32 v70, v70
    v_fract_f32 v71, v71
    v_cos_f32 v68, v68
    v_cos_f32 v69, v69
    v_cos_f32 v70, v70
    v_cos_f32 v71, v71
    v_mul_f32 v68, 0x03800000, v68
    v_mul_f32 v69, 0x03800000, v69
    v_mul_f32 v70, 0x03800000, v70
    v_mul_f32 v71, 0x03800000, v71
    v_cvt_pk_bf16_f32 v76, v68, v69
    v_cvt_pk_bf16_f32 v77, v70, v71
    v_lshrrev_b32 v68, 5, v76
    v_lshrrev_b32 v69, 5, v77
    v_bfi_b32 v76, s97, v68, v76
    v_bfi_b32 v77, s97, v69, v77
    v_lshl_or_b32 v84, v76, 21, v84
    v_lshlrev_b32 v68, 5, v76
    v_lshl_or_b32 v86, v77, 21, v86
    v_lshlrev_b32 v69, 5, v77
    v_and_or_b32 v85, v68, s95, v85
    v_and_or_b32 v87, v69, s95, v87
    s_waitcnt lgkmcnt(12)
    v_mul_u32_u24_sdwa v13, 3, v5 dst_sel:DWORD dst_unused:UNUSED_PAD src0_sel:DWORD src1_sel:WORD_0
    v_lshlrev_b32_sdwa v14, 2, v5 dst_sel:DWORD dst_unused:UNUSED_PAD src0_sel:DWORD src1_sel:WORD_1
    v_mul_u32_u24_sdwa v15, s87, v13 dst_sel:DWORD dst_unused:UNUSED_PAD src0_sel:DWORD src1_sel:WORD_1
    v_mul_u32_u24_sdwa v13, 10, v13 dst_sel:DWORD dst_unused:UNUSED_PAD src0_sel:DWORD src1_sel:WORD_1
    v_add_u32 v15, v15, v14
    v_lshlrev_b32_sdwa v13, v13, v108 dst_sel:DWORD dst_unused:UNUSED_PAD src0_sel:DWORD src1_sel:WORD_1
    ds_write_b32 v15, v84 offset:47136
    ds_or_b32 v14, v13 offset:10272
    v_and_b32 v5, 0xffff, v113
    ds_add_rtn_u32 v5, v5, v4 offset:5120
    s_waitcnt lgkmcnt(12)
    v_mul_u32_u24_sdwa v10, 3, v6 dst_sel:DWORD dst_unused:UNUSED_PAD src0_sel:DWORD src1_sel:WORD_0
    v_lshlrev_b32_sdwa v11, 2, v6 dst_sel:DWORD dst_unused:UNUSED_PAD src0_sel:DWORD src1_sel:WORD_1
    v_mul_u32_u24_sdwa v12, s87, v10 dst_sel:DWORD dst_unused:UNUSED_PAD src0_sel:DWORD src1_sel:WORD_1
    v_mul_u32_u24_sdwa v10, 10, v10 dst_sel:DWORD dst_unused:UNUSED_PAD src0_sel:DWORD src1_sel:WORD_1
    v_add_u32 v12, v12, v11
    v_lshlrev_b32_sdwa v10, v10, v109 dst_sel:DWORD dst_unused:UNUSED_PAD src0_sel:DWORD src1_sel:WORD_1
    ds_write_b32 v12, v85 offset:47136
    ds_or_b32 v11, v10 offset:10272
    v_and_b32 v6, 0xffff, v114
    ds_add_rtn_u32 v6, v6, v4 offset:5120
    s_waitcnt lgkmcnt(12)
    v_mul_u32_u24_sdwa v13, 3, v7 dst_sel:DWORD dst_unused:UNUSED_PAD src0_sel:DWORD src1_sel:WORD_0
    v_lshlrev_b32_sdwa v14, 2, v7 dst_sel:DWORD dst_unused:UNUSED_PAD src0_sel:DWORD src1_sel:WORD_1
    v_mul_u32_u24_sdwa v15, s87, v13 dst_sel:DWORD dst_unused:UNUSED_PAD src0_sel:DWORD src1_sel:WORD_1
    v_mul_u32_u24_sdwa v13, 10, v13 dst_sel:DWORD dst_unused:UNUSED_PAD src0_sel:DWORD src1_sel:WORD_1
    v_add_u32 v15, v15, v14
    v_lshlrev_b32_sdwa v13, v13, v110 dst_sel:DWORD dst_unused:UNUSED_PAD src0_sel:DWORD src1_sel:WORD_1
    ds_write_b32 v15, v86 offset:47136
    ds_or_b32 v14, v13 offset:10272
    s_mov_b32 s38, 49152
    buffer_store_dwordx4 v[44:47], v1, s[20:23], s38 offen sc1
    v_and_b32 v7, 0xffff, v115
    ds_add_rtn_u32 v7, v7, v4 offset:5120
    s_waitcnt lgkmcnt(12)
    v_mul_u32_u24_sdwa v10, 3, v8 dst_sel:DWORD dst_unused:UNUSED_PAD src0_sel:DWORD src1_sel:WORD_0
    v_lshlrev_b32_sdwa v11, 2, v8 dst_sel:DWORD dst_unused:UNUSED_PAD src0_sel:DWORD src1_sel:WORD_1
    v_mul_u32_u24_sdwa v12, s87, v10 dst_sel:DWORD dst_unused:UNUSED_PAD src0_sel:DWORD src1_sel:WORD_1
    v_mul_u32_u24_sdwa v10, 10, v10 dst_sel:DWORD dst_unused:UNUSED_PAD src0_sel:DWORD src1_sel:WORD_1
    v_add_u32 v12, v12, v11
    v_lshlrev_b32_sdwa v10, v10, v111 dst_sel:DWORD dst_unused:UNUSED_PAD src0_sel:DWORD src1_sel:WORD_1
    ds_write_b32 v12, v87 offset:47136
    ds_or_b32 v11, v10 offset:10272
    v_and_b32 v8, 0xffff, v116
    ds_add_rtn_u32 v8, v8, v4 offset:5120
    s_cmp_eq_u32 s36, 1.0
    s_cbranch_scc1 L_p1_kernel_f1_2
    v_lshlrev_b32 v68, 16, v24
    v_and_b32 v69, 0xffff0000, v24
    v_lshlrev_b32 v70, 16, v25
    v_and_b32 v71, 0xffff0000, v25
    v_mul_f32 v68, s36, v68
    v_mul_f32 v69, s36, v69
    v_mul_f32 v70, s36, v70
    v_mul_f32 v71, s36, v71
    v_cvt_pk_bf16_f32 v24, v68, v69
    v_cvt_pk_bf16_f32 v25, v70, v71
L_p1_kernel_f1_2:
    v_lshlrev_b32 v68, 16, v24
    v_and_b32 v69, 0xffff0000, v24
    v_lshlrev_b32 v70, 16, v25
    v_and_b32 v71, 0xffff0000, v25
    v_mul_f32 v68, 0.15915494, v68
    v_mul_f32 v69, 0.15915494, v69
    v_mul_f32 v70, 0.15915494, v70
    v_mul_f32 v71, 0.15915494, v71
    v_fract_f32 v68, v68
    v_fract_f32 v69, v69
    v_fract_f32 v70, v70
    v_fract_f32 v71, v71
    v_cos_f32 v68, v68
    v_cos_f32 v69, v69
    v_cos_f32 v70, v70
    v_cos_f32 v71, v71
    v_mul_f32 v68, 0x03800000, v68
    v_mul_f32 v69, 0x03800000, v69
    v_mul_f32 v70, 0x03800000, v70
    v_mul_f32 v71, 0x03800000, v71
    v_cvt_pk_bf16_f32 v76, v68, v69
    v_cvt_pk_bf16_f32 v77, v70, v71
    v_lshrrev_b32 v68, 5, v76
    v_lshrrev_b32 v69, 5, v77
    v_bfi_b32 v76, s97, v68, v76
    v_bfi_b32 v77, s97, v69, v77
    v_lshl_or_b32 v88, v76, 21, v88
    v_lshlrev_b32 v68, 5, v76
    v_lshl_or_b32 v90, v77, 21, v90
    v_lshlrev_b32 v69, 5, v77
    v_and_or_b32 v89, v68, s95, v89
    v_and_or_b32 v91, v69, s95, v91
    s_waitcnt lgkmcnt(12)
    v_mul_u32_u24_sdwa v13, 3, v9 dst_sel:DWORD dst_unused:UNUSED_PAD src0_sel:DWORD src1_sel:WORD_0
    v_lshlrev_b32_sdwa v14, 2, v9 dst_sel:DWORD dst_unused:UNUSED_PAD src0_sel:DWORD src1_sel:WORD_1
    v_mul_u32_u24_sdwa v15, s87, v13 dst_sel:DWORD dst_unused:UNUSED_PAD src0_sel:DWORD src1_sel:WORD_1
    v_mul_u32_u24_sdwa v13, 10, v13 dst_sel:DWORD dst_unused:UNUSED_PAD src0_sel:DWORD src1_sel:WORD_1
    v_add_u32 v15, v15, v14
    v_lshlrev_b32_sdwa v13, v13, v112 dst_sel:DWORD dst_unused:UNUSED_PAD src0_sel:DWORD src1_sel:WORD_1
    ds_write_b32 v15, v88 offset:47136
    ds_or_b32 v14, v13 offset:10272
    v_and_b32 v9, 0xffff, v117
    ds_add_rtn_u32 v9, v9, v4 offset:5120
    s_waitcnt lgkmcnt(12)
    v_mul_u32_u24_sdwa v10, 3, v5 dst_sel:DWORD dst_unused:UNUSED_PAD src0_sel:DWORD src1_sel:WORD_0
    v_lshlrev_b32_sdwa v11, 2, v5 dst_sel:DWORD dst_unused:UNUSED_PAD src0_sel:DWORD src1_sel:WORD_1
    v_mul_u32_u24_sdwa v12, s87, v10 dst_sel:DWORD dst_unused:UNUSED_PAD src0_sel:DWORD src1_sel:WORD_1
    v_mul_u32_u24_sdwa v10, 10, v10 dst_sel:DWORD dst_unused:UNUSED_PAD src0_sel:DWORD src1_sel:WORD_1
    v_add_u32 v12, v12, v11
    v_lshlrev_b32_sdwa v10, v10, v113 dst_sel:DWORD dst_unused:UNUSED_PAD src0_sel:DWORD src1_sel:WORD_1
    ds_write_b32 v12, v89 offset:47136
    ds_or_b32 v11, v10 offset:10272
    s_mov_b32 s38, 65536
    buffer_store_dwordx4 v[48:51], v1, s[20:23], s38 offen sc1
    v_and_b32 v5, 0xffff, v118
    ds_add_rtn_u32 v5, v5, v4 offset:5120
    s_waitcnt lgkmcnt(12)
    v_mul_u32_u24_sdwa v13, 3, v6 dst_sel:DWORD dst_unused:UNUSED_PAD src0_sel:DWORD src1_sel:WORD_0
    v_lshlrev_b32_sdwa v14, 2, v6 dst_sel:DWORD dst_unused:UNUSED_PAD src0_sel:DWORD src1_sel:WORD_1
    v_mul_u32_u24_sdwa v15, s87, v13 dst_sel:DWORD dst_unused:UNUSED_PAD src0_sel:DWORD src1_sel:WORD_1
    v_mul_u32_u24_sdwa v13, 10, v13 dst_sel:DWORD dst_unused:UNUSED_PAD src0_sel:DWORD src1_sel:WORD_1
    v_add_u32 v15, v15, v14
    v_lshlrev_b32_sdwa v13, v13, v114 dst_sel:DWORD dst_unused:UNUSED_PAD src0_sel:DWORD src1_sel:WORD_1
    ds_write_b32 v15, v90 offset:47136
    ds_or_b32 v14, v13 offset:10272
    v_and_b32 v6, 0xffff, v119
    ds_add_rtn_u32 v6, v6, v4 offset:5120
    s_waitcnt lgkmcnt(12)
    v_mul_u32_u24_sdwa v10, 3, v7 dst_sel:DWORD dst_unused:UNUSED_PAD src0_sel:DWORD src1_sel:WORD_0
    v_lshlrev_b32_sdwa v11, 2, v7 dst_sel:DWORD dst_unused:UNUSED_PAD src0_sel:DWORD src1_sel:WORD_1
    v_mul_u32_u24_sdwa v12, s87, v10 dst_sel:DWORD dst_unused:UNUSED_PAD src0_sel:DWORD src1_sel:WORD_1
    v_mul_u32_u24_sdwa v10, 10, v10 dst_sel:DWORD dst_unused:UNUSED_PAD src0_sel:DWORD src1_sel:WORD_1
    v_add_u32 v12, v12, v11
    v_lshlrev_b32_sdwa v10, v10, v115 dst_sel:DWORD dst_unused:UNUSED_PAD src0_sel:DWORD src1_sel:WORD_1
    ds_write_b32 v12, v91 offset:47136
    ds_or_b32 v11, v10 offset:10272
    v_and_b32 v7, 0xffff, v120
    ds_add_rtn_u32 v7, v7, v4 offset:5120
    s_cmp_eq_u32 s36, 1.0
    s_cbranch_scc1 L_p1_kernel_f1_3
    v_lshlrev_b32 v68, 16, v26
    v_and_b32 v69, 0xffff0000, v26
    v_lshlrev_b32 v70, 16, v27
    v_and_b32 v71, 0xffff0000, v27
    v_mul_f32 v68, s36, v68
    v_mul_f32 v69, s36, v69
    v_mul_f32 v70, s36, v70
    v_mul_f32 v71, s36, v71
    v_cvt_pk_bf16_f32 v26, v68, v69
    v_cvt_pk_bf16_f32 v27, v70, v71
L_p1_kernel_f1_3:
    v_lshlrev_b32 v68, 16, v26
    v_and_b32 v69, 0xffff0000, v26
    v_lshlrev_b32 v70, 16, v27
    v_and_b32 v71, 0xffff0000, v27
    v_mul_f32 v68, 0.15915494, v68
    v_mul_f32 v69, 0.15915494, v69
    v_mul_f32 v70, 0.15915494, v70
    v_mul_f32 v71, 0.15915494, v71
    v_fract_f32 v68, v68
    v_fract_f32 v69, v69
    v_fract_f32 v70, v70
    v_fract_f32 v71, v71
    v_cos_f32 v68, v68
    v_cos_f32 v69, v69
    v_cos_f32 v70, v70
    v_cos_f32 v71, v71
    v_mul_f32 v68, 0x03800000, v68
    v_mul_f32 v69, 0x03800000, v69
    v_mul_f32 v70, 0x03800000, v70
    v_mul_f32 v71, 0x03800000, v71
    v_cvt_pk_bf16_f32 v76, v68, v69
    v_cvt_pk_bf16_f32 v77, v70, v71
    v_lshrrev_b32 v68, 5, v76
    v_lshrrev_b32 v69, 5, v77
    v_bfi_b32 v76, s97, v68, v76
    v_bfi_b32 v77, s97, v69, v77
    v_lshl_or_b32 v92, v76, 21, v92
    v_lshlrev_b32 v68, 5, v76
    v_lshl_or_b32 v94, v77, 21, v94
    v_lshlrev_b32 v69, 5, v77
    v_and_or_b32 v93, v68, s95, v93
    v_and_or_b32 v95, v69, s95, v95
    s_waitcnt lgkmcnt(12)
    v_mul_u32_u24_sdwa v13, 3, v8 dst_sel:DWORD dst_unused:UNUSED_PAD src0_sel:DWORD src1_sel:WORD_0
    v_lshlrev_b32_sdwa v14, 2, v8 dst_sel:DWORD dst_unused:UNUSED_PAD src0_sel:DWORD src1_sel:WORD_1
    v_mul_u32_u24_sdwa v15, s87, v13 dst_sel:DWORD dst_unused:UNUSED_PAD src0_sel:DWORD src1_sel:WORD_1
    v_mul_u32_u24_sdwa v13, 10, v13 dst_sel:DWORD dst_unused:UNUSED_PAD src0_sel:DWORD src1_sel:WORD_1
    v_add_u32 v15, v15, v14
    v_lshlrev_b32_sdwa v13, v13, v116 dst_sel:DWORD dst_unused:UNUSED_PAD src0_sel:DWORD src1_sel:WORD_1
    ds_write_b32 v15, v92 offset:47136
    ds_or_b32 v14, v13 offset:10272
    s_mov_b32 s38, 81920
    buffer_store_dwordx4 v[52:55], v1, s[20:23], s38 offen sc1
    v_and_b32 v8, 0xffff, v121
    ds_add_rtn_u32 v8, v8, v4 offset:5120
    s_waitcnt lgkmcnt(12)
    v_mul_u32_u24_sdwa v10, 3, v9 dst_sel:DWORD dst_unused:UNUSED_PAD src0_sel:DWORD src1_sel:WORD_0
    v_lshlrev_b32_sdwa v11, 2, v9 dst_sel:DWORD dst_unused:UNUSED_PAD src0_sel:DWORD src1_sel:WORD_1
    v_mul_u32_u24_sdwa v12, s87, v10 dst_sel:DWORD dst_unused:UNUSED_PAD src0_sel:DWORD src1_sel:WORD_1
    v_mul_u32_u24_sdwa v10, 10, v10 dst_sel:DWORD dst_unused:UNUSED_PAD src0_sel:DWORD src1_sel:WORD_1
    v_add_u32 v12, v12, v11
    v_lshlrev_b32_sdwa v10, v10, v117 dst_sel:DWORD dst_unused:UNUSED_PAD src0_sel:DWORD src1_sel:WORD_1
    ds_write_b32 v12, v93 offset:47136
    ds_or_b32 v11, v10 offset:10272
    v_and_b32 v9, 0xffff, v122
    ds_add_rtn_u32 v9, v9, v4 offset:5120
    s_waitcnt lgkmcnt(12)
    v_mul_u32_u24_sdwa v13, 3, v5 dst_sel:DWORD dst_unused:UNUSED_PAD src0_sel:DWORD src1_sel:WORD_0
    v_lshlrev_b32_sdwa v14, 2, v5 dst_sel:DWORD dst_unused:UNUSED_PAD src0_sel:DWORD src1_sel:WORD_1
    v_mul_u32_u24_sdwa v15, s87, v13 dst_sel:DWORD dst_unused:UNUSED_PAD src0_sel:DWORD src1_sel:WORD_1
    v_mul_u32_u24_sdwa v13, 10, v13 dst_sel:DWORD dst_unused:UNUSED_PAD src0_sel:DWORD src1_sel:WORD_1
    v_add_u32 v15, v15, v14
    v_lshlrev_b32_sdwa v13, v13, v118 dst_sel:DWORD dst_unused:UNUSED_PAD src0_sel:DWORD src1_sel:WORD_1
    ds_write_b32 v15, v94 offset:47136
    ds_or_b32 v14, v13 offset:10272
    v_and_b32 v5, 0xffff, v123
    ds_add_rtn_u32 v5, v5, v4 offset:5120
    s_waitcnt lgkmcnt(12)
    v_mul_u32_u24_sdwa v10, 3, v6 dst_sel:DWORD dst_unused:UNUSED_PAD src0_sel:DWORD src1_sel:WORD_0
    v_lshlrev_b32_sdwa v11, 2, v6 dst_sel:DWORD dst_unused:UNUSED_PAD src0_sel:DWORD src1_sel:WORD_1
    v_mul_u32_u24_sdwa v12, s87, v10 dst_sel:DWORD dst_unused:UNUSED_PAD src0_sel:DWORD src1_sel:WORD_1
    v_mul_u32_u24_sdwa v10, 10, v10 dst_sel:DWORD dst_unused:UNUSED_PAD src0_sel:DWORD src1_sel:WORD_1
    v_add_u32 v12, v12, v11
    v_lshlrev_b32_sdwa v10, v10, v119 dst_sel:DWORD dst_unused:UNUSED_PAD src0_sel:DWORD src1_sel:WORD_1
    ds_write_b32 v12, v95 offset:47136
    ds_or_b32 v11, v10 offset:10272
    s_mov_b32 s38, 98304
    buffer_store_dwordx4 v[56:59], v1, s[20:23], s38 offen sc1
    v_and_b32 v6, 0xffff, v124
    ds_add_rtn_u32 v6, v6, v4 offset:5120
    s_waitcnt vmcnt(8)
    s_cmp_eq_u32 s36, 1.0
    s_cbranch_scc1 L_p1_kernel_f1_4
    v_lshlrev_b32 v68, 16, v72
    v_and_b32 v69, 0xffff0000, v72
    v_lshlrev_b32 v70, 16, v73
    v_and_b32 v71, 0xffff0000, v73
    v_mul_f32 v68, s36, v68
    v_mul_f32 v69, s36, v69
    v_mul_f32 v70, s36, v70
    v_mul_f32 v71, s36, v71
    v_cvt_pk_bf16_f32 v72, v68, v69
    v_cvt_pk_bf16_f32 v73, v70, v71
L_p1_kernel_f1_4:
    v_lshlrev_b32 v68, 16, v72
    v_and_b32 v69, 0xffff0000, v72
    v_lshlrev_b32 v70, 16, v73
    v_and_b32 v71, 0xffff0000, v73
    v_mul_f32 v68, 0.15915494, v68
    v_mul_f32 v69, 0.15915494, v69
    v_mul_f32 v70, 0.15915494, v70
    v_mul_f32 v71, 0.15915494, v71
    v_fract_f32 v68, v68
    v_fract_f32 v69, v69
    v_fract_f32 v70, v70
    v_fract_f32 v71, v71
    v_cos_f32 v68, v68
    v_cos_f32 v69, v69
    v_cos_f32 v70, v70
    v_cos_f32 v71, v71
    v_mul_f32 v68, 0x03800000, v68
    v_mul_f32 v69, 0x03800000, v69
    v_mul_f32 v70, 0x03800000, v70
    v_mul_f32 v71, 0x03800000, v71
    v_cvt_pk_bf16_f32 v76, v68, v69
    v_cvt_pk_bf16_f32 v77, v70, v71
    v_lshrrev_b32 v68, 5, v76
    v_lshrrev_b32 v69, 5, v77
    v_bfi_b32 v76, s97, v68, v76
    v_bfi_b32 v77, s97, v69, v77
    v_lshl_or_b32 v96, v76, 21, v96
    v_lshlrev_b32 v68, 5, v76
    v_lshl_or_b32 v98, v77, 21, v98
    v_lshlrev_b32 v69, 5, v77
    v_and_or_b32 v97, v68, s95, v97
    v_and_or_b32 v99, v69, s95, v99
    s_waitcnt lgkmcnt(12)
    v_mul_u32_u24_sdwa v13, 3, v7 dst_sel:DWORD dst_unused:UNUSED_PAD src0_sel:DWORD src1_sel:WORD_0
    v_lshlrev_b32_sdwa v14, 2, v7 dst_sel:DWORD dst_unused:UNUSED_PAD src0_sel:DWORD src1_sel:WORD_1
    v_mul_u32_u24_sdwa v15, s87, v13 dst_sel:DWORD dst_unused:UNUSED_PAD src0_sel:DWORD src1_sel:WORD_1
    v_mul_u32_u24_sdwa v13, 10, v13 dst_sel:DWORD dst_unused:UNUSED_PAD src0_sel:DWORD src1_sel:WORD_1
    v_add_u32 v15, v15, v14
    v_lshlrev_b32_sdwa v13, v13, v120 dst_sel:DWORD dst_unused:UNUSED_PAD src0_sel:DWORD src1_sel:WORD_1
    ds_write_b32 v15, v96 offset:47136
    ds_or_b32 v14, v13 offset:10272
    v_and_b32 v7, 0xffff, v125
    ds_add_rtn_u32 v7, v7, v4 offset:5120
    s_waitcnt lgkmcnt(12)
    v_mul_u32_u24_sdwa v10, 3, v8 dst_sel:DWORD dst_unused:UNUSED_PAD src0_sel:DWORD src1_sel:WORD_0
    v_lshlrev_b32_sdwa v11, 2, v8 dst_sel:DWORD dst_unused:UNUSED_PAD src0_sel:DWORD src1_sel:WORD_1
    v_mul_u32_u24_sdwa v12, s87, v10 dst_sel:DWORD dst_unused:UNUSED_PAD src0_sel:DWORD src1_sel:WORD_1
    v_mul_u32_u24_sdwa v10, 10, v10 dst_sel:DWORD dst_unused:UNUSED_PAD src0_sel:DWORD src1_sel:WORD_1
    v_add_u32 v12, v12, v11
    v_lshlrev_b32_sdwa v10, v10, v121 dst_sel:DWORD dst_unused:UNUSED_PAD src0_sel:DWORD src1_sel:WORD_1
    ds_write_b32 v12, v97 offset:47136
    ds_or_b32 v11, v10 offset:10272
    v_and_b32 v8, 0xffff, v126
    ds_add_rtn_u32 v8, v8, v4 offset:5120
    s_waitcnt lgkmcnt(12)
    v_mul_u32_u24_sdwa v13, 3, v9 dst_sel:DWORD dst_unused:UNUSED_PAD src0_sel:DWORD src1_sel:WORD_0
    v_lshlrev_b32_sdwa v14, 2, v9 dst_sel:DWORD dst_unused:UNUSED_PAD src0_sel:DWORD src1_sel:WORD_1
    v_mul_u32_u24_sdwa v15, s87, v13 dst_sel:DWORD dst_unused:UNUSED_PAD src0_sel:DWORD src1_sel:WORD_1
    v_mul_u32_u24_sdwa v13, 10, v13 dst_sel:DWORD dst_unused:UNUSED_PAD src0_sel:DWORD src1_sel:WORD_1
    v_add_u32 v15, v15, v14
    v_lshlrev_b32_sdwa v13, v13, v122 dst_sel:DWORD dst_unused:UNUSED_PAD src0_sel:DWORD src1_sel:WORD_1
    ds_write_b32 v15, v98 offset:47136
    ds_or_b32 v14, v13 offset:10272
    s_mov_b32 s38, 114688
    buffer_store_dwordx4 v[60:63], v1, s[20:23], s38 offen sc1
    v_and_b32 v9, 0xffff, v127
    ds_add_rtn_u32 v9, v9, v4 offset:5120
    s_waitcnt lgkmcnt(12)
    v_mul_u32_u24_sdwa v10, 3, v5 dst_sel:DWORD dst_unused:UNUSED_PAD src0_sel:DWORD src1_sel:WORD_0
    v_lshlrev_b32_sdwa v11, 2, v5 dst_sel:DWORD dst_unused:UNUSED_PAD src0_sel:DWORD src1_sel:WORD_1
    v_mul_u32_u24_sdwa v12, s87, v10 dst_sel:DWORD dst_unused:UNUSED_PAD src0_sel:DWORD src1_sel:WORD_1
    v_mul_u32_u24_sdwa v10, 10, v10 dst_sel:DWORD dst_unused:UNUSED_PAD src0_sel:DWORD src1_sel:WORD_1
    v_add_u32 v12, v12, v11
    v_lshlrev_b32_sdwa v10, v10, v123 dst_sel:DWORD dst_unused:UNUSED_PAD src0_sel:DWORD src1_sel:WORD_1
    ds_write_b32 v12, v99 offset:47136
    ds_or_b32 v11, v10 offset:10272
    s_waitcnt vmcnt(8)
    s_cmp_eq_u32 s36, 1.0
    s_cbranch_scc1 L_p1_kernel_f1_5
    v_lshlrev_b32 v68, 16, v74
    v_and_b32 v69, 0xffff0000, v74
    v_lshlrev_b32 v70, 16, v75
    v_and_b32 v71, 0xffff0000, v75
    v_mul_f32 v68, s36, v68
    v_mul_f32 v69, s36, v69
    v_mul_f32 v70, s36, v70
    v_mul_f32 v71, s36, v71
    v_cvt_pk_bf16_f32 v74, v68, v69
    v_cvt_pk_bf16_f32 v75, v70, v71
L_p1_kernel_f1_5:
    v_lshlrev_b32 v68, 16, v74
    v_and_b32 v69, 0xffff0000, v74
    v_lshlrev_b32 v70, 16, v75
    v_and_b32 v71, 0xffff0000, v75
    v_mul_f32 v68, 0.15915494, v68
    v_mul_f32 v69, 0.15915494, v69
    v_mul_f32 v70, 0.15915494, v70
    v_mul_f32 v71, 0.15915494, v71
    v_fract_f32 v68, v68
    v_fract_f32 v69, v69
    v_fract_f32 v70, v70
    v_fract_f32 v71, v71
    v_cos_f32 v68, v68
    v_cos_f32 v69, v69
    v_cos_f32 v70, v70
    v_cos_f32 v71, v71
    v_mul_f32 v68, 0x03800000, v68
    v_mul_f32 v69, 0x03800000, v69
    v_mul_f32 v70, 0x03800000, v70
    v_mul_f32 v71, 0x03800000, v71
    v_cvt_pk_bf16_f32 v76, v68, v69
    v_cvt_pk_bf16_f32 v77, v70, v71
    v_lshrrev_b32 v68, 5, v76
    v_lshrrev_b32 v69, 5, v77
    v_bfi_b32 v76, s97, v68, v76
    v_bfi_b32 v77, s97, v69, v77
    v_lshl_or_b32 v100, v76, 21, v100
    v_lshlrev_b32 v68, 5, v76
    v_lshl_or_b32 v102, v77, 21, v102
    v_lshlrev_b32 v69, 5, v77
    v_and_or_b32 v101, v68, s95, v101
    v_and_or_b32 v103, v69, s95, v103
    s_waitcnt lgkmcnt(11)
    v_mul_u32_u24_sdwa v13, 3, v6 dst_sel:DWORD dst_unused:UNUSED_PAD src0_sel:DWORD src1_sel:WORD_0
    v_lshlrev_b32_sdwa v14, 2, v6 dst_sel:DWORD dst_unused:UNUSED_PAD src0_sel:DWORD src1_sel:WORD_1
    v_mul_u32_u24_sdwa v15, s87, v13 dst_sel:DWORD dst_unused:UNUSED_PAD src0_sel:DWORD src1_sel:WORD_1
    v_mul_u32_u24_sdwa v13, 10, v13 dst_sel:DWORD dst_unused:UNUSED_PAD src0_sel:DWORD src1_sel:WORD_1
    v_add_u32 v15, v15, v14
    v_lshlrev_b32_sdwa v13, v13, v124 dst_sel:DWORD dst_unused:UNUSED_PAD src0_sel:DWORD src1_sel:WORD_1
    ds_write_b32 v15, v100 offset:47136
    ds_or_b32 v14, v13 offset:10272
    s_waitcnt lgkmcnt(10)
    v_mul_u32_u24_sdwa v10, 3, v7 dst_sel:DWORD dst_unused:UNUSED_PAD src0_sel:DWORD src1_sel:WORD_0
    v_lshlrev_b32_sdwa v11, 2, v7 dst_sel:DWORD dst_unused:UNUSED_PAD src0_sel:DWORD src1_sel:WORD_1
    v_mul_u32_u24_sdwa v12, s87, v10 dst_sel:DWORD dst_unused:UNUSED_PAD src0_sel:DWORD src1_sel:WORD_1
    v_mul_u32_u24_sdwa v10, 10, v10 dst_sel:DWORD dst_unused:UNUSED_PAD src0_sel:DWORD src1_sel:WORD_1
    v_add_u32 v12, v12, v11
    v_lshlrev_b32_sdwa v10, v10, v125 dst_sel:DWORD dst_unused:UNUSED_PAD src0_sel:DWORD src1_sel:WORD_1
    ds_write_b32 v12, v101 offset:47136
    ds_or_b32 v11, v10 offset:10272
    s_mov_b32 s38, 131072
    s_mov_b64 exec, s[88:89]
    buffer_store_dwordx4 v[64:67], v1, s[20:23], s38 offen sc1
    s_mov_b64 exec, -1
    s_waitcnt lgkmcnt(9)
    v_mul_u32_u24_sdwa v13, 3, v8 dst_sel:DWORD dst_unused:UNUSED_PAD src0_sel:DWORD src1_sel:WORD_0
    v_lshlrev_b32_sdwa v14, 2, v8 dst_sel:DWORD dst_unused:UNUSED_PAD src0_sel:DWORD src1_sel:WORD_1
    v_mul_u32_u24_sdwa v15, s87, v13 dst_sel:DWORD dst_unused:UNUSED_PAD src0_sel:DWORD src1_sel:WORD_1
    v_mul_u32_u24_sdwa v13, 10, v13 dst_sel:DWORD dst_unused:UNUSED_PAD src0_sel:DWORD src1_sel:WORD_1
    v_add_u32 v15, v15, v14
    v_lshlrev_b32_sdwa v13, v13, v126 dst_sel:DWORD dst_unused:UNUSED_PAD src0_sel:DWORD src1_sel:WORD_1
    ds_write_b32 v15, v102 offset:47136
    ds_or_b32 v14, v13 offset:10272
    s_waitcnt lgkmcnt(8)
    v_mul_u32_u24_sdwa v10, 3, v9 dst_sel:DWORD dst_unused:UNUSED_PAD src0_sel:DWORD src1_sel:WORD_0
    v_lshlrev_b32_sdwa v11, 2, v9 dst_sel:DWORD dst_unused:UNUSED_PAD src0_sel:DWORD src1_sel:WORD_1
    v_mul_u32_u24_sdwa v12, s87, v10 dst_sel:DWORD dst_unused:UNUSED_PAD src0_sel:DWORD src1_sel:WORD_1
    v_mul_u32_u24_sdwa v10, 10, v10 dst_sel:DWORD dst_unused:UNUSED_PAD src0_sel:DWORD src1_sel:WORD_1
    v_add_u32 v12, v12, v11
    v_lshlrev_b32_sdwa v10, v10, v127 dst_sel:DWORD dst_unused:UNUSED_PAD src0_sel:DWORD src1_sel:WORD_1
    ds_write_b32 v12, v103 offset:47136
    ds_or_b32 v11, v10 offset:10272
    s_waitcnt lgkmcnt(0)
    s_barrier
    v_mov_b32 v9, 0
    ds_read_b128 v[10:13], v9 offset:10240
    v_lshlrev_b32 v5, 2, v0
    v_add_u32 v5, 10272, v5
    v_add_u32 v6, 73728, v5
    v_add_u32 v7, 20480, v5
    v_add_u32 v8, 20480, v6
    ds_read2st64_b32 v[80:81], v5 offset0:0 offset1:144
    ds_read2st64_b32 v[82:83], v6 offset0:0 offset1:144
    ds_read2st64_b32 v[84:85], v5 offset0:16 offset1:160
    ds_read2st64_b32 v[86:87], v6 offset0:16 offset1:160
    ds_read2st64_b32 v[88:89], v5 offset0:32 offset1:176
    ds_read2st64_b32 v[90:91], v6 offset0:32 offset1:176
    ds_read2st64_b32 v[92:93], v5 offset0:48 offset1:192
    ds_read2st64_b32 v[94:95], v6 offset0:48 offset1:192
    s_waitcnt lgkmcnt(8)
    v_add3_u32 v10, v10, v11, v12
    v_add3_u32 v10, v10, v13, 23
    v_mul_u32_u24 v10, v4, v10
    v_lshrrev_b32 v10, 16, v10
    v_and_b32 v10, -8, v10
    v_subrev_u32 v10, 8192, v10
    v_cmp_lt_u32 s[90:91], v0, v10
    ds_read2st64_b32 v[96:97], v5 offset0:64 offset1:208
    ds_read2st64_b32 v[98:99], v6 offset0:64 offset1:208
    ds_read2st64_b32 v[100:101], v7 offset0:0 offset1:144
    ds_read2st64_b32 v[102:103], v8 offset0:0 offset1:144
    ds_read2st64_b32 v[104:105], v7 offset0:16 offset1:160
    ds_read2st64_b32 v[106:107], v8 offset0:16 offset1:160
    ds_read2st64_b32 v[108:109], v7 offset0:32 offset1:176
    ds_read2st64_b32 v[110:111], v8 offset0:32 offset1:176
    ds_read2st64_b32 v[112:113], v7 offset0:48 offset1:192
    ds_read2st64_b32 v[114:115], v8 offset0:48 offset1:192
    s_waitcnt lgkmcnt(15)
    s_mov_b32 s38, 0
    buffer_store_dwordx4 v[80:83], v1, s[24:27], s38 offen sc1
    s_waitcnt lgkmcnt(14)
    s_mov_b32 s38, 16384
    buffer_store_dwordx4 v[84:87], v1, s[24:27], s38 offen sc1
    s_waitcnt lgkmcnt(12)
    s_mov_b32 s38, 32768
    buffer_store_dwordx4 v[88:91], v1, s[24:27], s38 offen sc1
    s_waitcnt lgkmcnt(10)
    s_mov_b32 s38, 49152
    buffer_store_dwordx4 v[92:95], v1, s[24:27], s38 offen sc1
    s_waitcnt lgkmcnt(8)
    s_mov_b32 s38, 65536
    buffer_store_dwordx4 v[96:99], v1, s[24:27], s38 offen sc1
    s_waitcnt lgkmcnt(6)
    s_mov_b32 s38, 81920
    buffer_store_dwordx4 v[100:103], v1, s[24:27], s38 offen sc1
    s_waitcnt lgkmcnt(4)
    s_mov_b32 s38, 98304
    buffer_store_dwordx4 v[104:107], v1, s[24:27], s38 offen sc1
    s_waitcnt lgkmcnt(2)
    s_mov_b32 s38, 114688
    buffer_store_dwordx4 v[108:111], v1, s[24:27], s38 offen sc1
    s_waitcnt lgkmcnt(0)
    s_mov_b32 s38, 131072
    s_mov_b64 exec, s[90:91]
    buffer_store_dwordx4 v[112:115], v1, s[24:27], s38 offen sc1
    s_mov_b64 exec, -1
L_p1_kernel_end:
    s_endpgm
.globl p2_kernel
.p2align 8
.type p2_kernel,@function
p2_kernel:
    s_cmp_ge_u32 s2, 256
    s_cbranch_scc1 L_p2_kernel_end
    s_setprio 3
    s_load_dwordx2 s[98:99], s[0:1], 104
    s_load_dwordx2 s[8:9], s[0:1], 0
    s_load_dwordx2 s[36:37], s[0:1], 24
    s_load_dwordx2 s[40:41], s[0:1], 88
    v_lshrrev_b32 v14, 6, v0
    v_and_b32 v15, 63, v0
    s_bfe_u32 s32, s2, 0x20001
    v_readfirstlane_b32 s14, v14
    s_and_b32 s33, s2, 1
    s_lshl_b32 s33, s33, 5
    s_lshr_b32 s13, s2, 3
    s_add_u32 s33, s33, s13
    v_and_b32 v17, 15, v0
    v_lshrrev_b32 v21, 2, v0
    v_bfe_u32 v18, v0, 1, 1
    v_and_b32 v19, 1, v0
    v_mul_u32_u24 v21, 10240, v21
    v_mad_u32_u24 v21, v18, 20, v21
    v_mad_u32_u24 v21, v19, 12, v21
    s_lshl_b32 s13, s32, 6
    s_add_u32 s13, s13, s33
    s_mul_i32 s13, s13, 40
    s_getpc_b64 s[4:5]
    s_lshr_b32 s3, s2, 3
    s_mul_i32 s3, s3, 6
    v_add_lshl_u32 v68, v0, s3, 7
    s_mov_b32 s6, L_code_end - p2_kernel - 256
    s_mov_b32 s7, 0x00020000
    v_cmp_gt_u32 vcc, 6, v0
    s_mov_b64 exec, vcc
    buffer_load_dword v68, v68, s[4:7], 0 offen
    s_mov_b64 exec, -1
    s_waitcnt lgkmcnt(0)
    s_add_u32 s4, s98, 83886080
    s_addc_u32 s5, s99, 0
    s_mov_b32 s6, 2621440
    s_mov_b32 s7, 0x00020000
    buffer_load_dwordx3 v[10:12], v21, s[4:7], s13 offen
    s_setprio 0
    v_lshrrev_b32 v22, 5, v0
    v_mul_u32_u24 v22, 13, v22
    v_cmp_gt_u32 vcc, 13, v17
    v_add_lshl_u32 v7, v22, v17, 2
    v_mov_b32 v23, 163840
    v_sub_u32 v7, 163836, v7
    v_mov_b32 v64, 4289683336
    v_cndmask_b32 v7, v23, v7, vcc
    v_cmp_eq_u32 vcc, 0, v15
    v_mov_b32 v9, 162160
    v_mov_b32 v65, 4289683464
    v_mov_b32 v80, 0
    v_cndmask_b32 v9, v23, v9, vcc
    ds_write_b32 v7, v64
    ds_write2_b32 v9, v80, v80 offset0:0 offset1:1
    ds_write2_b32 v9, v80, v65 offset0:2 offset1:3
    s_waitcnt lgkmcnt(0)
    s_barrier
    s_add_u32 s88, s98, 87031808
    s_addc_u32 s89, s99, 0
    v_lshlrev_b32 v100, 2, v15
    v_and_b32 v104, 3, v0
    v_mul_u32_u24 v104, 48, v104
    v_lshrrev_b32 v20, 4, v0
    v_lshlrev_b32 v20, 3, v20
    s_load_dwordx4 s[92:95], s[88:89], 192
    s_mov_b32 s10, 6400000
    s_mov_b32 s11, 0x00020000
    v_bfe_u32 v24, v0, 3, 1
    v_add_u32 v20, v20, v24
    v_and_b32 v24, 7, v0
    v_mul_u32_u24 v1, 151680, v20
    v_lshl_add_u32 v1, v24, 4, v1
    v_lshlrev_b32 v24, 27, v24
    v_sub_u32 v1, v1, v24
    v_lshl_add_u32 v58, v19, 2, 8
    v_lshrrev_b32 v56, 1, v0
    v_mul_u32_u24 v56, 151680, v56
    v_lshl_add_u32 v56, v58, 4, v56
    v_and_b32 v24, 3, v0
    v_add_lshl_u32 v57, v24, 1, 27
    v_lshlrev_b32 v24, 4, v24
    v_sub_u32 v57, v24, v57
    s_mul_i32 s15, s32, 1600000
    s_mov_b32 s17, 0
    s_mov_b32 s100, 0
    s_mov_b32 s4, s98
    s_mov_b32 s5, s99
    s_mov_b32 s6, 77660160
    s_mov_b32 s72, 0
    s_mov_b32 s73, 303360
    s_mov_b32 s74, 606720
    s_mov_b32 s75, 910080
    v_mov_b32 v6, 4
    s_cmp_lt_u32 s14, 8
    s_cbranch_scc1 L_p2_kernel_nz
    v_mov_b32 v81, 0
    v_mov_b32 v82, 0
    v_mov_b32 v83, 0
    v_lshlrev_b32 v14, 4, v0
    ds_write_b128 v14, v[80:83] offset:53776
    v_add_u32 v14, 8192, v14
    ds_write_b128 v14, v[80:83] offset:53776
    v_add_u32 v14, 8192, v14
    ds_write_b128 v14, v[80:83] offset:53776
    v_add_u32 v14, 8192, v14
    ds_write_b128 v14, v[80:83] offset:53776
    v_add_u32 v14, 8192, v14
    ds_write_b128 v14, v[80:83] offset:53776
    v_add_u32 v14, 8192, v14
    ds_write_b128 v14, v[80:83] offset:53776
    v_add_u32 v14, 8192, v14
    ds_write_b128 v14, v[80:83] offset:53776
    v_add_u32 v14, 8192, v14
    ds_write_b128 v14, v[80:83] offset:53776
    v_add_u32 v14, 8192, v14
    ds_write_b128 v14, v[80:83] offset:53776
    v_add_u32 v14, 8192, v14
    ds_write_b128 v14, v[80:83] offset:53776
    v_add_u32 v14, 8192, v14
    ds_write_b128 v14, v[80:83] offset:53776
    v_add_u32 v14, 8192, v14
    ds_write_b128 v14, v[80:83] offset:53776
    v_add_u32 v14, 8192, v14
    v_cmp_gt_u32 vcc, 624, v0
    s_mov_b64 exec, vcc
    ds_write_b128 v14, v[80:83] offset:53776
    v_add_u32 v14, 8192, v14
    s_mov_b64 exec, -1
L_p2_kernel_nz:
    ds_add_u32 v9, v6 offset:8
    s_waitcnt vmcnt(0)
    s_cmp_lt_u32 s17, 5
    s_cselect_b32 s13, -1, 0
    s_add_u32 s17, s17, 1
    v_and_b32 v13, s13, v10
    v_mov_b32 v10, v11
    v_mov_b32 v11, v12
    v_mov_b32_dpp v12, v13 quad_perm:[1,0,3,2] row_mask:0xf bank_mask:0xf
    v_mov_b32_dpp v52, v13 quad_perm:[0,0,2,2] row_mask:0xf bank_mask:0xf
    v_min_u32_sdwa v126, 8, v13 dst_sel:DWORD dst_unused:UNUSED_PAD src0_sel:DWORD src1_sel:WORD_1
    v_subrev_u32_sdwa v53, v58, v52 dst_sel:DWORD dst_unused:UNUSED_PAD src0_sel:DWORD src1_sel:WORD_1
    v_lshlrev_b32_sdwa v52, 4, v52 dst_sel:DWORD dst_unused:UNUSED_PAD src0_sel:DWORD src1_sel:WORD_0
    v_cmp_lt_i32 vcc, 0, v53
    v_add_u32 v126, -1, v126
    v_min_i32 v53, 4, v53
    v_lshl_add_u32 v70, v126, 27, v52
    v_mbcnt_lo_u32_b32 v126, vcc_lo, 0
    v_add_u32 v52, v52, v56
    v_mbcnt_hi_u32_b32 v126, vcc_hi, v126
    s_bcnt1_i32_b64 s13, vcc
    v_lshl_add_u32 v52, v53, 27, v52
    s_mov_b32 s97, 16
    v_lshlrev_b32 v126, 4, v126
    s_cmp_le_u32 s13, 16
    s_cbranch_scc1 L_p2_kernel_nc1
    s_call_b64 s[20:21], L_p2_kernel_six
L_p2_kernel_nc1:
    v_cndmask_b32 v126, 4, v126, vcc
    ds_permute_b32 v59, v126, v52
    v_add_u32_dpp v126, v70, v1 row_newbcast:0 row_mask:0xf bank_mask:0xf
    v_mov_b32 v32, 0
    s_nop 0
    v_add_u32_dpp v126, v70, v1 row_newbcast:2 row_mask:0xf bank_mask:0xc
    v_cmp_le_i32 vcc, 0, v126
    v_and_b32 v126, 0x87ffffff, v126
    s_mov_b64 exec, vcc
    buffer_load_dwordx4 v[32:35], v126, s[4:7], s72 offen
    s_mov_b64 exec, -1
    global_load_dword v100, v100, s[88:89] offset:1024
    global_load_dwordx2 v[104:105], v104, s[88:89]
    v_add_u32_dpp v126, v70, v1 row_newbcast:4 row_mask:0xf bank_mask:0xf
    v_mov_b32 v36, 0
    s_nop 0
    v_add_u32_dpp v126, v70, v1 row_newbcast:6 row_mask:0xf bank_mask:0xc
    v_cmp_le_i32 vcc, 0, v126
    v_and_b32 v126, 0x87ffffff, v126
    s_mov_b64 exec, vcc
    buffer_load_dwordx4 v[36:39], v126, s[4:7], s73 offen
    s_mov_b64 exec, -1
    v_add_u32_dpp v126, v70, v1 row_newbcast:8 row_mask:0xf bank_mask:0xf
    v_mov_b32 v40, 0
    s_nop 0
    v_add_u32_dpp v126, v70, v1 row_newbcast:10 row_mask:0xf bank_mask:0xc
    v_cmp_le_i32 vcc, 0, v126
    v_and_b32 v126, 0x87ffffff, v126
    s_mov_b64 exec, vcc
    buffer_load_dwordx4 v[40:43], v126, s[4:7], s74 offen
    s_mov_b64 exec, -1
    v_add_u32_dpp v126, v70, v1 row_newbcast:12 row_mask:0xf bank_mask:0xf
    v_mov_b32 v44, 0
    s_nop 0
    v_add_u32_dpp v126, v70, v1 row_newbcast:14 row_mask:0xf bank_mask:0xc
    v_cmp_le_i32 vcc, 0, v126
    v_and_b32 v126, 0x87ffffff, v126
    s_mov_b64 exec, vcc
    buffer_load_dwordx4 v[44:47], v126, s[4:7], s75 offen
    s_mov_b64 exec, -1
    s_waitcnt lgkmcnt(0)
    v_add_u32_dpp v126, v59, v57 quad_perm:[0,0,0,0] row_mask:0xf bank_mask:0xf
    v_mov_b32 v48, 0
    v_cmp_le_i32 vcc, 0, v126
    v_and_b32 v126, 0x87ffffff, v126
    s_mov_b64 exec, vcc
    buffer_load_dwordx4 v[48:51], v126, s[4:7], 0 offen
    s_mov_b64 exec, -1
    v_lshlrev_b32 v5, 2, v15
    v_and_b32 v2, 0x7c, v5
    v_sub_u32 v4, 404, v22
    v_mul_u32_u24 v4, 132, v4
    v_add_u32 v4, v4, v2
    v_add_u32 v2, 4289683340, v2
    v_add_u32 v5, 4, v5
    v_mul_u32_u24 v3, 768, v22
    s_lshl_b32 s13, s2, 8
    s_and_b32 s13, s13, 2048
    s_add_u32 s13, s13, 161788
    v_mov_b32 v66, s13
    v_mov_b32 v30, 0x1fff8
    s_movk_i32 s28, 0xffc
    s_mov_b32 s12, 0
    s_mul_i32 s23, s14, 54
    s_add_u32 s23, s23, 6881
    s_mov_b32 s16, s15
    s_mov_b32 s34, 0x55555555
    s_mov_b32 s35, 0x55555555
    s_lshr_b32 s13, s14, 2
    s_bitcmp1_b32 3, s13
    s_cselect_b32 s19, 1, 0
    s_mov_b32 s90, 0
    s_mov_b64 s[82:83], 0
    s_waitcnt vmcnt(4)
    v_max_u32_sdwa v101, v100, v100 dst_sel:DWORD dst_unused:UNUSED_PAD src0_sel:BYTE_0 src1_sel:BYTE_1
    v_max_u32_sdwa v100, v100, v100 dst_sel:DWORD dst_unused:UNUSED_PAD src0_sel:BYTE_2 src1_sel:BYTE_3
    v_lshlrev_b32 v106, 16, v104
    v_max_u32 v100, v100, v101
    v_and_b32 v107, 0xffff0000, v104
    v_lshlrev_b32 v108, 16, v105
    v_max_u32_dpp v100, v100, v100 row_ror:8 row_mask:0xf bank_mask:0xf
    v_and_b32 v109, 0xffff0000, v105
    v_add_f32 v101, abs(v106), abs(v107)
    v_max_u32_dpp v100, v100, v100 row_ror:4 row_mask:0xf bank_mask:0xf
    v_add_f32 v102, abs(v108), abs(v109)
    v_add_f32 v101, v101, v102
    v_max_u32_dpp v100, v100, v100 row_ror:2 row_mask:0xf bank_mask:0xf
    s_nop 1
    v_max_u32_dpp v100, v100, v100 row_ror:1 row_mask:0xf bank_mask:0xf
    v_frexp_exp_i32_f32 v101, v101
    v_readlane_b32 s68, v100, 0
    v_readlane_b32 s69, v100, 16
    v_readlane_b32 s70, v100, 32
    v_readlane_b32 s71, v100, 48
    s_max_u32 s68, s68, s69
    s_max_u32 s70, s70, s71
    s_max_u32 s68, s68, s70
    s_sub_u32 s68, 132, s68
    s_movk_i32 s70, -116
    v_mov_b32 v102, 116
    v_sub_u32 v122, s68, v101
    v_med3_i32 v122, v122, s70, v102
    v_add_u32 v100, 8, v122
    v_ldexp_f32 v106, v106, v100
    v_ldexp_f32 v107, v107, v100
    v_ldexp_f32 v108, v108, v100
    v_ldexp_f32 v109, v109, v100
    v_cvt_pk_bf16_f32 v120, v106, v107
    v_cvt_pk_bf16_f32 v121, v108, v109
L_p2_kernel_sc1:
    s_waitcnt vmcnt(4)
    v_lshrrev_b32 v15, 10, v32
    v_lshrrev_b32 v16, 20, v32
    v_bitop3_b32 v14, v32, s28, v66 bitop3:0x6a
    v_bitop3_b32 v15, v15, s28, v66 bitop3:0x6a
    v_bitop3_b32 v16, v16, s28, v66 bitop3:0x6a
    ds_add_rtn_u32 v17, v14, v6 offset:2052
    ds_add_rtn_u32 v18, v15, v6 offset:2052
    ds_add_rtn_u32 v19, v16, v6 offset:2052
    s_waitcnt vmcnt(3)
    v_lshrrev_b32 v21, 10, v36
    v_lshrrev_b32 v22, 20, v36
    v_bitop3_b32 v20, v36, s28, v66 bitop3:0x6a
    v_bitop3_b32 v21, v21, s28, v66 bitop3:0x6a
    v_bitop3_b32 v22, v22, s28, v66 bitop3:0x6a
    ds_add_rtn_u32 v23, v20, v6 offset:2052
    ds_add_rtn_u32 v24, v21, v6 offset:2052
    ds_add_rtn_u32 v25, v22, v6 offset:2052
    s_waitcnt lgkmcnt(3)
    v_max3_u32 v72, v17, v18, v19
    v_cmp_le_u32 vcc, v65, v72
    s_cbranch_vccz L_p2_kernel_ovp0_f
    v_cmp_le_u32 s[68:69], v65, v17
    v_cmp_le_u32 s[70:71], v65, v18
    v_cmp_le_u32 vcc, v65, v19
    s_add_u32 s32, s12, s23
    v_mbcnt_lo_u32_b32 v76, s68, 0
    v_mbcnt_lo_u32_b32 v77, s70, 0
    v_mbcnt_lo_u32_b32 v78, vcc_lo, 0
    s_bcnt1_i32_b64 s33, s[68:69]
    s_bcnt1_i32_b64 s26, s[70:71]
    s_bcnt1_i32_b64 s13, vcc
    v_mbcnt_hi_u32_b32 v76, s69, v76
    v_mbcnt_hi_u32_b32 v77, s71, v77
    v_mbcnt_hi_u32_b32 v78, vcc_hi, v78
    s_add_u32 s33, s33, s32
    s_add_u32 s26, s26, s33
    s_add_u32 s13, s13, s26
    v_add_lshl_u32 v76, v76, s32, 3
    s_sub_u32 s13, s13, s23
    v_add_lshl_u32 v77, v77, s33, 3
    s_cmp_gt_u32 s13, 54
    v_add_lshl_u32 v78, v78, s26, 3
    s_cbranch_scc1 L_p2_kernel_ovp0
    s_mov_b32 s12, s13
    s_mov_b64 exec, s[68:69]
    ds_write2_b32 v76, v33, v14 offset0:0 offset1:1
    s_mov_b64 exec, s[70:71]
    ds_write2_b32 v77, v34, v15 offset0:0 offset1:1
    s_mov_b64 exec, vcc
    ds_write2_b32 v78, v35, v16 offset0:0 offset1:1
    s_mov_b64 exec, -1
L_p2_kernel_ovp0_r:
    v_min_u32 v17, v65, v17
    v_min_u32 v18, v65, v18
    v_min_u32 v19, v65, v19
L_p2_kernel_ovp0_f:
    v_mad_u32_u24 v17, v14, 33, v17
    ds_write_b32 v17, v33
    v_mad_u32_u24 v18, v15, 33, v18
    ds_write_b32 v18, v34
    v_mad_u32_u24 v19, v16, 33, v19
    ds_write_b32 v19, v35
    s_waitcnt vmcnt(2)
    v_lshrrev_b32 v15, 10, v40
    v_lshrrev_b32 v16, 20, v40
    v_bitop3_b32 v14, v40, s28, v66 bitop3:0x6a
    v_bitop3_b32 v15, v15, s28, v66 bitop3:0x6a
    v_bitop3_b32 v16, v16, s28, v66 bitop3:0x6a
    ds_add_rtn_u32 v17, v14, v6 offset:2052
    ds_add_rtn_u32 v18, v15, v6 offset:2052
    ds_add_rtn_u32 v19, v16, v6 offset:2052
    s_waitcnt lgkmcnt(6)
    v_max3_u32 v72, v23, v24, v25
    v_cmp_le_u32 vcc, v65, v72
    s_cbranch_vccz L_p2_kernel_ovp1_f
    v_cmp_le_u32 s[68:69], v65, v23
    v_cmp_le_u32 s[70:71], v65, v24
    v_cmp_le_u32 vcc, v65, v25
    s_add_u32 s32, s12, s23
    v_mbcnt_lo_u32_b32 v76, s68, 0
    v_mbcnt_lo_u32_b32 v77, s70, 0
    v_mbcnt_lo_u32_b32 v78, vcc_lo, 0
    s_bcnt1_i32_b64 s33, s[68:69]
    s_bcnt1_i32_b64 s26, s[70:71]
    s_bcnt1_i32_b64 s13, vcc
    v_mbcnt_hi_u32_b32 v76, s69, v76
    v_mbcnt_hi_u32_b32 v77, s71, v77
    v_mbcnt_hi_u32_b32 v78, vcc_hi, v78
    s_add_u32 s33, s33, s32
    s_add_u32 s26, s26, s33
    s_add_u32 s13, s13, s26
    v_add_lshl_u32 v76, v76, s32, 3
    s_sub_u32 s13, s13, s23
    v_add_lshl_u32 v77, v77, s33, 3
    s_cmp_gt_u32 s13, 54
    v_add_lshl_u32 v78, v78, s26, 3
    s_cbranch_scc1 L_p2_kernel_ovp1
    s_mov_b32 s12, s13
    s_mov_b64 exec, s[68:69]
    ds_write2_b32 v76, v37, v20 offset0:0 offset1:1
    s_mov_b64 exec, s[70:71]
    ds_write2_b32 v77, v38, v21 offset0:0 offset1:1
    s_mov_b64 exec, vcc
    ds_write2_b32 v78, v39, v22 offset0:0 offset1:1
    s_mov_b64 exec, -1
L_p2_kernel_ovp1_r:
    v_min_u32 v23, v65, v23
    v_min_u32 v24, v65, v24
    v_min_u32 v25, v65, v25
L_p2_kernel_ovp1_f:
    v_mad_u32_u24 v23, v20, 33, v23
    ds_write_b32 v23, v37
    v_mad_u32_u24 v24, v21, 33, v24
    ds_write_b32 v24, v38
    v_mad_u32_u24 v25, v22, 33, v25
    ds_write_b32 v25, v39
    s_waitcnt vmcnt(1)
    v_lshrrev_b32 v21, 10, v44
    v_lshrrev_b32 v22, 20, v44
    v_bitop3_b32 v20, v44, s28, v66 bitop3:0x6a
    v_bitop3_b32 v21, v21, s28, v66 bitop3:0x6a
    v_bitop3_b32 v22, v22, s28, v66 bitop3:0x6a
    ds_add_rtn_u32 v23, v20, v6 offset:2052
    ds_add_rtn_u32 v24, v21, v6 offset:2052
    ds_add_rtn_u32 v25, v22, v6 offset:2052
    s_waitcnt lgkmcnt(6)
    v_max3_u32 v72, v17, v18, v19
    v_cmp_le_u32 vcc, v65, v72
    s_cbranch_vccz L_p2_kernel_ovp2_f
    v_cmp_le_u32 s[68:69], v65, v17
    v_cmp_le_u32 s[70:71], v65, v18
    v_cmp_le_u32 vcc, v65, v19
    s_add_u32 s32, s12, s23
    v_mbcnt_lo_u32_b32 v76, s68, 0
    v_mbcnt_lo_u32_b32 v77, s70, 0
    v_mbcnt_lo_u32_b32 v78, vcc_lo, 0
    s_bcnt1_i32_b64 s33, s[68:69]
    s_bcnt1_i32_b64 s26, s[70:71]
    s_bcnt1_i32_b64 s13, vcc
    v_mbcnt_hi_u32_b32 v76, s69, v76
    v_mbcnt_hi_u32_b32 v77, s71, v77
    v_mbcnt_hi_u32_b32 v78, vcc_hi, v78
    s_add_u32 s33, s33, s32
    s_add_u32 s26, s26, s33
    s_add_u32 s13, s13, s26
    v_add_lshl_u32 v76, v76, s32, 3
    s_sub_u32 s13, s13, s23
    v_add_lshl_u32 v77, v77, s33, 3
    s_cmp_gt_u32 s13, 54
    v_add_lshl_u32 v78, v78, s26, 3
    s_cbranch_scc1 L_p2_kernel_ovp2
    s_mov_b32 s12, s13
    s_mov_b64 exec, s[68:69]
    ds_write2_b32 v76, v41, v14 offset0:0 offset1:1
    s_mov_b64 exec, s[70:71]
    ds_write2_b32 v77, v42, v15 offset0:0 offset1:1
    s_mov_b64 exec, vcc
    ds_write2_b32 v78, v43, v16 offset0:0 offset1:1
    s_mov_b64 exec, -1
L_p2_kernel_ovp2_r:
    v_min_u32 v17, v65, v17
    v_min_u32 v18, v65, v18
    v_min_u32 v19, v65, v19
L_p2_kernel_ovp2_f:
    v_mad_u32_u24 v17, v14, 33, v17
    ds_write_b32 v17, v41
    v_mad_u32_u24 v18, v15, 33, v18
    ds_write_b32 v18, v42
    v_mad_u32_u24 v19, v16, 33, v19
    ds_write_b32 v19, v43
    s_waitcnt vmcnt(0)
    v_lshrrev_b32 v15, 10, v48
    v_lshrrev_b32 v16, 20, v48
    v_bitop3_b32 v14, v48, s28, v66 bitop3:0x6a
    v_bitop3_b32 v15, v15, s28, v66 bitop3:0x6a
    v_bitop3_b32 v16, v16, s28, v66 bitop3:0x6a
    ds_add_rtn_u32 v17, v14, v6 offset:2052
    ds_add_rtn_u32 v18, v15, v6 offset:2052
    ds_add_rtn_u32 v19, v16, v6 offset:2052
    s_waitcnt lgkmcnt(6)
    v_max3_u32 v72, v23, v24, v25
    v_cmp_le_u32 vcc, v65, v72
    s_cbranch_vccz L_p2_kernel_ovp3_f
    v_cmp_le_u32 s[68:69], v65, v23
    v_cmp_le_u32 s[70:71], v65, v24
    v_cmp_le_u32 vcc, v65, v25
    s_add_u32 s32, s12, s23
    v_mbcnt_lo_u32_b32 v76, s68, 0
    v_mbcnt_lo_u32_b32 v77, s70, 0
    v_mbcnt_lo_u32_b32 v78, vcc_lo, 0
    s_bcnt1_i32_b64 s33, s[68:69]
    s_bcnt1_i32_b64 s26, s[70:71]
    s_bcnt1_i32_b64 s13, vcc
    v_mbcnt_hi_u32_b32 v76, s69, v76
    v_mbcnt_hi_u32_b32 v77, s71, v77
    v_mbcnt_hi_u32_b32 v78, vcc_hi, v78
    s_add_u32 s33, s33, s32
    s_add_u32 s26, s26, s33
    s_add_u32 s13, s13, s26
    v_add_lshl_u32 v76, v76, s32, 3
    s_sub_u32 s13, s13, s23
    v_add_lshl_u32 v77, v77, s33, 3
    s_cmp_gt_u32 s13, 54
    v_add_lshl_u32 v78, v78, s26, 3
    s_cbranch_scc1 L_p2_kernel_ovp3
    s_mov_b32 s12, s13
    s_mov_b64 exec, s[68:69]
    ds_write2_b32 v76, v45, v20 offset0:0 offset1:1
    s_mov_b64 exec, s[70:71]
    ds_write2_b32 v77, v46, v21 offset0:0 offset1:1
    s_mov_b64 exec, vcc
    ds_write2_b32 v78, v47, v22 offset0:0 offset1:1
    s_mov_b64 exec, -1
L_p2_kernel_ovp3_r:
    v_min_u32 v23, v65, v23
    v_min_u32 v24, v65, v24
    v_min_u32 v25, v65, v25
L_p2_kernel_ovp3_f:
    v_mad_u32_u24 v23, v20, 33, v23
    ds_write_b32 v23, v45
    v_mad_u32_u24 v24, v21, 33, v24
    ds_write_b32 v24, v46
    v_mad_u32_u24 v25, v22, 33, v25
    ds_write_b32 v25, v47
    s_waitcnt lgkmcnt(3)
    v_max3_u32 v72, v17, v18, v19
    v_cmp_le_u32 vcc, v65, v72
    s_cbranch_vccz L_p2_kernel_ovp4_f
    v_cmp_le_u32 s[68:69], v65, v17
    v_cmp_le_u32 s[70:71], v65, v18
    v_cmp_le_u32 vcc, v65, v19
    s_add_u32 s32, s12, s23
    v_mbcnt_lo_u32_b32 v76, s68, 0
    v_mbcnt_lo_u32_b32 v77, s70, 0
    v_mbcnt_lo_u32_b32 v78, vcc_lo, 0
    s_bcnt1_i32_b64 s33, s[68:69]
    s_bcnt1_i32_b64 s26, s[70:71]
    s_bcnt1_i32_b64 s13, vcc
    v_mbcnt_hi_u32_b32 v76, s69, v76
    v_mbcnt_hi_u32_b32 v77, s71, v77
    v_mbcnt_hi_u32_b32 v78, vcc_hi, v78
    s_add_u32 s33, s33, s32
    s_add_u32 s26, s26, s33
    s_add_u32 s13, s13, s26
    v_add_lshl_u32 v76, v76, s32, 3
    s_sub_u32 s13, s13, s23
    v_add_lshl_u32 v77, v77, s33, 3
    s_cmp_gt_u32 s13, 54
    v_add_lshl_u32 v78, v78, s26, 3
    s_cbranch_scc1 L_p2_kernel_ovp4
    s_mov_b32 s12, s13
    s_mov_b64 exec, s[68:69]
    ds_write2_b32 v76, v49, v14 offset0:0 offset1:1
    s_mov_b64 exec, s[70:71]
    ds_write2_b32 v77, v50, v15 offset0:0 offset1:1
    s_mov_b64 exec, vcc
    ds_write2_b32 v78, v51, v16 offset0:0 offset1:1
    s_mov_b64 exec, -1
L_p2_kernel_ovp4_r:
    v_min_u32 v17, v65, v17
    v_min_u32 v18, v65, v18
    v_min_u32 v19, v65, v19
L_p2_kernel_ovp4_f:
    v_mad_u32_u24 v17, v14, 33, v17
    ds_write_b32 v17, v49
    v_mad_u32_u24 v18, v15, 33, v18
    ds_write_b32 v18, v50
    v_mad_u32_u24 v19, v16, 33, v19
    ds_write_b32 v19, v51
    s_cmp_eq_u32 s100, 0
    s_cbranch_scc1 L_p2_kernel_b5p
    s_call_b64 s[24:25], L_p2_kernel_bin5
L_p2_kernel_b5p:
    s_setprio 0
    ds_add_u32 v9, v6 offset:0
    s_branch L_p2_kernel_b0
L_p2_kernel_loop:
    v_readfirstlane_b32 s13, v55
    s_add_u32 s32, s90, 0
    s_cmp_ge_u32 s13, s32
    s_cbranch_scc1 L_p2_kernel_aw2_x
    s_branch L_p2_kernel_aw2_a
L_p2_kernel_aw2:
    s_sleep 10
L_p2_kernel_aw2_a:
    ds_read_b32 v126, v9 offset:4
    s_waitcnt lgkmcnt(0)
    v_readfirstlane_b32 s13, v126
    s_cmp_lt_u32 s13, s32
    s_cbranch_scc1 L_p2_kernel_aw2
L_p2_kernel_aw2_x:
    s_setprio 0
    s_waitcnt vmcnt(4)
    v_lshrrev_b32 v15, 10, v32
    v_lshrrev_b32 v16, 20, v32
    v_bitop3_b32 v14, v32, s28, v66 bitop3:0x6a
    v_bitop3_b32 v15, v15, s28, v66 bitop3:0x6a
    v_bitop3_b32 v16, v16, s28, v66 bitop3:0x6a
    ds_add_rtn_u32 v17, v14, v6 offset:2052
    ds_add_rtn_u32 v18, v15, v6 offset:2052
    ds_add_rtn_u32 v19, v16, v6 offset:2052
    s_waitcnt vmcnt(3)
    v_lshrrev_b32 v21, 10, v36
    v_lshrrev_b32 v22, 20, v36
    v_bitop3_b32 v20, v36, s28, v66 bitop3:0x6a
    v_bitop3_b32 v21, v21, s28, v66 bitop3:0x6a
    v_bitop3_b32 v22, v22, s28, v66 bitop3:0x6a
    ds_add_rtn_u32 v23, v20, v6 offset:2052
    ds_add_rtn_u32 v24, v21, v6 offset:2052
    ds_add_rtn_u32 v25, v22, v6 offset:2052
    s_waitcnt lgkmcnt(3)
    v_max3_u32 v72, v17, v18, v19
    v_cmp_le_u32 vcc, v65, v72
    s_cbranch_vccz L_p2_kernel_ov0_f
    v_cmp_le_u32 s[68:69], v65, v17
    v_cmp_le_u32 s[70:71], v65, v18
    v_cmp_le_u32 vcc, v65, v19
    s_add_u32 s32, s12, s23
    v_mbcnt_lo_u32_b32 v76, s68, 0
    v_mbcnt_lo_u32_b32 v77, s70, 0
    v_mbcnt_lo_u32_b32 v78, vcc_lo, 0
    s_bcnt1_i32_b64 s33, s[68:69]
    s_bcnt1_i32_b64 s26, s[70:71]
    s_bcnt1_i32_b64 s13, vcc
    v_mbcnt_hi_u32_b32 v76, s69, v76
    v_mbcnt_hi_u32_b32 v77, s71, v77
    v_mbcnt_hi_u32_b32 v78, vcc_hi, v78
    s_add_u32 s33, s33, s32
    s_add_u32 s26, s26, s33
    s_add_u32 s13, s13, s26
    v_add_lshl_u32 v76, v76, s32, 3
    s_sub_u32 s13, s13, s23
    v_add_lshl_u32 v77, v77, s33, 3
    s_cmp_gt_u32 s13, 54
    v_add_lshl_u32 v78, v78, s26, 3
    s_cbranch_scc1 L_p2_kernel_ov0
    s_mov_b32 s12, s13
    s_mov_b64 exec, s[68:69]
    ds_write2_b32 v76, v33, v14 offset0:0 offset1:1
    s_mov_b64 exec, s[70:71]
    ds_write2_b32 v77, v34, v15 offset0:0 offset1:1
    s_mov_b64 exec, vcc
    ds_write2_b32 v78, v35, v16 offset0:0 offset1:1
    s_mov_b64 exec, -1
L_p2_kernel_ov0_r:
    v_min_u32 v17, v65, v17
    v_min_u32 v18, v65, v18
    v_min_u32 v19, v65, v19
L_p2_kernel_ov0_f:
    v_mad_u32_u24 v17, v14, 33, v17
    ds_write_b32 v17, v33
    v_mad_u32_u24 v18, v15, 33, v18
    ds_write_b32 v18, v34
    v_mad_u32_u24 v19, v16, 33, v19
    ds_write_b32 v19, v35
    s_waitcnt vmcnt(2)
    v_lshrrev_b32 v15, 10, v40
    v_lshrrev_b32 v16, 20, v40
    v_bitop3_b32 v14, v40, s28, v66 bitop3:0x6a
    v_bitop3_b32 v15, v15, s28, v66 bitop3:0x6a
    v_bitop3_b32 v16, v16, s28, v66 bitop3:0x6a
    ds_add_rtn_u32 v17, v14, v6 offset:2052
    ds_add_rtn_u32 v18, v15, v6 offset:2052
    ds_add_rtn_u32 v19, v16, v6 offset:2052
    s_waitcnt lgkmcnt(6)
    v_max3_u32 v72, v23, v24, v25
    v_cmp_le_u32 vcc, v65, v72
    s_cbranch_vccz L_p2_kernel_ov1_f
    v_cmp_le_u32 s[68:69], v65, v23
    v_cmp_le_u32 s[70:71], v65, v24
    v_cmp_le_u32 vcc, v65, v25
    s_add_u32 s32, s12, s23
    v_mbcnt_lo_u32_b32 v76, s68, 0
    v_mbcnt_lo_u32_b32 v77, s70, 0
    v_mbcnt_lo_u32_b32 v78, vcc_lo, 0
    s_bcnt1_i32_b64 s33, s[68:69]
    s_bcnt1_i32_b64 s26, s[70:71]
    s_bcnt1_i32_b64 s13, vcc
    v_mbcnt_hi_u32_b32 v76, s69, v76
    v_mbcnt_hi_u32_b32 v77, s71, v77
    v_mbcnt_hi_u32_b32 v78, vcc_hi, v78
    s_add_u32 s33, s33, s32
    s_add_u32 s26, s26, s33
    s_add_u32 s13, s13, s26
    v_add_lshl_u32 v76, v76, s32, 3
    s_sub_u32 s13, s13, s23
    v_add_lshl_u32 v77, v77, s33, 3
    s_cmp_gt_u32 s13, 54
    v_add_lshl_u32 v78, v78, s26, 3
    s_cbranch_scc1 L_p2_kernel_ov1
    s_mov_b32 s12, s13
    s_mov_b64 exec, s[68:69]
    ds_write2_b32 v76, v37, v20 offset0:0 offset1:1
    s_mov_b64 exec, s[70:71]
    ds_write2_b32 v77, v38, v21 offset0:0 offset1:1
    s_mov_b64 exec, vcc
    ds_write2_b32 v78, v39, v22 offset0:0 offset1:1
    s_mov_b64 exec, -1
L_p2_kernel_ov1_r:
    v_min_u32 v23, v65, v23
    v_min_u32 v24, v65, v24
    v_min_u32 v25, v65, v25
L_p2_kernel_ov1_f:
    v_mad_u32_u24 v23, v20, 33, v23
    ds_write_b32 v23, v37
    v_mad_u32_u24 v24, v21, 33, v24
    ds_write_b32 v24, v38
    v_mad_u32_u24 v25, v22, 33, v25
    ds_write_b32 v25, v39
    s_waitcnt vmcnt(1)
    v_lshrrev_b32 v21, 10, v44
    v_lshrrev_b32 v22, 20, v44
    v_bitop3_b32 v20, v44, s28, v66 bitop3:0x6a
    v_bitop3_b32 v21, v21, s28, v66 bitop3:0x6a
    v_bitop3_b32 v22, v22, s28, v66 bitop3:0x6a
    ds_add_rtn_u32 v23, v20, v6 offset:2052
    ds_add_rtn_u32 v24, v21, v6 offset:2052
    ds_add_rtn_u32 v25, v22, v6 offset:2052
    s_waitcnt lgkmcnt(6)
    v_max3_u32 v72, v17, v18, v19
    v_cmp_le_u32 vcc, v65, v72
    s_cbranch_vccz L_p2_kernel_ov2_f
    v_cmp_le_u32 s[68:69], v65, v17
    v_cmp_le_u32 s[70:71], v65, v18
    v_cmp_le_u32 vcc, v65, v19
    s_add_u32 s32, s12, s23
    v_mbcnt_lo_u32_b32 v76, s68, 0
    v_mbcnt_lo_u32_b32 v77, s70, 0
    v_mbcnt_lo_u32_b32 v78, vcc_lo, 0
    s_bcnt1_i32_b64 s33, s[68:69]
    s_bcnt1_i32_b64 s26, s[70:71]
    s_bcnt1_i32_b64 s13, vcc
    v_mbcnt_hi_u32_b32 v76, s69, v76
    v_mbcnt_hi_u32_b32 v77, s71, v77
    v_mbcnt_hi_u32_b32 v78, vcc_hi, v78
    s_add_u32 s33, s33, s32
    s_add_u32 s26, s26, s33
    s_add_u32 s13, s13, s26
    v_add_lshl_u32 v76, v76, s32, 3
    s_sub_u32 s13, s13, s23
    v_add_lshl_u32 v77, v77, s33, 3
    s_cmp_gt_u32 s13, 54
    v_add_lshl_u32 v78, v78, s26, 3
    s_cbranch_scc1 L_p2_kernel_ov2
    s_mov_b32 s12, s13
    s_mov_b64 exec, s[68:69]
    ds_write2_b32 v76, v41, v14 offset0:0 offset1:1
    s_mov_b64 exec, s[70:71]
    ds_write2_b32 v77, v42, v15 offset0:0 offset1:1
    s_mov_b64 exec, vcc
    ds_write2_b32 v78, v43, v16 offset0:0 offset1:1
    s_mov_b64 exec, -1
L_p2_kernel_ov2_r:
    v_min_u32 v17, v65, v17
    v_min_u32 v18, v65, v18
    v_min_u32 v19, v65, v19
L_p2_kernel_ov2_f:
    v_mad_u32_u24 v17, v14, 33, v17
    ds_write_b32 v17, v41
    v_mad_u32_u24 v18, v15, 33, v18
    ds_write_b32 v18, v42
    v_mad_u32_u24 v19, v16, 33, v19
    ds_write_b32 v19, v43
    s_waitcnt vmcnt(0)
    v_lshrrev_b32 v15, 10, v48
    v_lshrrev_b32 v16, 20, v48
    v_bitop3_b32 v14, v48, s28, v66 bitop3:0x6a
    v_bitop3_b32 v15, v15, s28, v66 bitop3:0x6a
    v_bitop3_b32 v16, v16, s28, v66 bitop3:0x6a
    ds_add_rtn_u32 v17, v14, v6 offset:2052
    ds_add_rtn_u32 v18, v15, v6 offset:2052
    ds_add_rtn_u32 v19, v16, v6 offset:2052
    s_waitcnt lgkmcnt(6)
    v_max3_u32 v72, v23, v24, v25
    v_cmp_le_u32 vcc, v65, v72
    s_cbranch_vccz L_p2_kernel_ov3_f
    v_cmp_le_u32 s[68:69], v65, v23
    v_cmp_le_u32 s[70:71], v65, v24
    v_cmp_le_u32 vcc, v65, v25
    s_add_u32 s32, s12, s23
    v_mbcnt_lo_u32_b32 v76, s68, 0
    v_mbcnt_lo_u32_b32 v77, s70, 0
    v_mbcnt_lo_u32_b32 v78, vcc_lo, 0
    s_bcnt1_i32_b64 s33, s[68:69]
    s_bcnt1_i32_b64 s26, s[70:71]
    s_bcnt1_i32_b64 s13, vcc
    v_mbcnt_hi_u32_b32 v76, s69, v76
    v_mbcnt_hi_u32_b32 v77, s71, v77
    v_mbcnt_hi_u32_b32 v78, vcc_hi, v78
    s_add_u32 s33, s33, s32
    s_add_u32 s26, s26, s33
    s_add_u32 s13, s13, s26
    v_add_lshl_u32 v76, v76, s32, 3
    s_sub_u32 s13, s13, s23
    v_add_lshl_u32 v77, v77, s33, 3
    s_cmp_gt_u32 s13, 54
    v_add_lshl_u32 v78, v78, s26, 3
    s_cbranch_scc1 L_p2_kernel_ov3
    s_mov_b32 s12, s13
    s_mov_b64 exec, s[68:69]
    ds_write2_b32 v76, v45, v20 offset0:0 offset1:1
    s_mov_b64 exec, s[70:71]
    ds_write2_b32 v77, v46, v21 offset0:0 offset1:1
    s_mov_b64 exec, vcc
    ds_write2_b32 v78, v47, v22 offset0:0 offset1:1
    s_mov_b64 exec, -1
L_p2_kernel_ov3_r:
    v_min_u32 v23, v65, v23
    v_min_u32 v24, v65, v24
    v_min_u32 v25, v65, v25
L_p2_kernel_ov3_f:
    v_mad_u32_u24 v23, v20, 33, v23
    ds_write_b32 v23, v45
    v_mad_u32_u24 v24, v21, 33, v24
    ds_write_b32 v24, v46
    v_mad_u32_u24 v25, v22, 33, v25
    ds_write_b32 v25, v47
    s_waitcnt lgkmcnt(3)
    v_max3_u32 v72, v17, v18, v19
    v_cmp_le_u32 vcc, v65, v72
    s_cbranch_vccz L_p2_kernel_ov4_f
    v_cmp_le_u32 s[68:69], v65, v17
    v_cmp_le_u32 s[70:71], v65, v18
    v_cmp_le_u32 vcc, v65, v19
    s_add_u32 s32, s12, s23
    v_mbcnt_lo_u32_b32 v76, s68, 0
    v_mbcnt_lo_u32_b32 v77, s70, 0
    v_mbcnt_lo_u32_b32 v78, vcc_lo, 0
    s_bcnt1_i32_b64 s33, s[68:69]
    s_bcnt1_i32_b64 s26, s[70:71]
    s_bcnt1_i32_b64 s13, vcc
    v_mbcnt_hi_u32_b32 v76, s69, v76
    v_mbcnt_hi_u32_b32 v77, s71, v77
    v_mbcnt_hi_u32_b32 v78, vcc_hi, v78
    s_add_u32 s33, s33, s32
    s_add_u32 s26, s26, s33
    s_add_u32 s13, s13, s26
    v_add_lshl_u32 v76, v76, s32, 3
    s_sub_u32 s13, s13, s23
    v_add_lshl_u32 v77, v77, s33, 3
    s_cmp_gt_u32 s13, 54
    v_add_lshl_u32 v78, v78, s26, 3
    s_cbranch_scc1 L_p2_kernel_ov4
    s_mov_b32 s12, s13
    s_mov_b64 exec, s[68:69]
    ds_write2_b32 v76, v49, v14 offset0:0 offset1:1
    s_mov_b64 exec, s[70:71]
    ds_write2_b32 v77, v50, v15 offset0:0 offset1:1
    s_mov_b64 exec, vcc
    ds_write2_b32 v78, v51, v16 offset0:0 offset1:1
    s_mov_b64 exec, -1
L_p2_kernel_ov4_r:
    v_min_u32 v17, v65, v17
    v_min_u32 v18, v65, v18
    v_min_u32 v19, v65, v19
L_p2_kernel_ov4_f:
    v_mad_u32_u24 v17, v14, 33, v17
    ds_write_b32 v17, v49
    v_mad_u32_u24 v18, v15, 33, v18
    ds_write_b32 v18, v50
    v_mad_u32_u24 v19, v16, 33, v19
    ds_write_b32 v19, v51
    s_cmp_lg_u32 s19, 0
    s_cbranch_scc1 L_p2_kernel_eg
    s_add_u32 s18, s15, 3840
    s_add_u32 s29, s15, 7680
    v_mov_b32_dpp v103, v8 row_newbcast:0 row_mask:0xf bank_mask:0xf
    v_cmp_ge_u32 vcc, s22, v5
    v_cmp_ge_u32 s[68:69], v103, v2
    v_and_b32 v100, 0x7f, v99
    v_and_b32 v102, 0x7f, v86
    v_lshl_add_u32 v100, v100, 3, v69
    v_lshl_add_u32 v102, v102, 3, v3
    v_cndmask_b32 v99, -1, v99, vcc
    v_cndmask_b32 v86, -1, v86, s[68:69]
    s_mov_b64 exec, vcc
    buffer_load_dwordx2 v[100:101], v100, s[8:11], s15 offen offset:0
    s_mov_b64 exec, s[68:69]
    buffer_load_dwordx2 v[102:103], v102, s[8:11], s15 offen offset:0
    s_mov_b64 exec, -1
    v_mov_b32_dpp v105, v8 row_newbcast:1 row_mask:0xf bank_mask:0xf
    v_mov_b32_dpp v107, v8 row_newbcast:2 row_mask:0xf bank_mask:0xf
    v_cmp_ge_u32 vcc, v105, v2
    v_cmp_ge_u32 s[68:69], v107, v2
    v_and_b32 v104, 0x7f, v87
    v_and_b32 v106, 0x7f, v88
    v_lshl_add_u32 v104, v104, 3, v3
    v_lshl_add_u32 v106, v106, 3, v3
    v_cndmask_b32 v87, -1, v87, vcc
    v_cndmask_b32 v88, -1, v88, s[68:69]
    s_mov_b64 exec, vcc
    buffer_load_dwordx2 v[104:105], v104, s[8:11], s15 offen offset:768
    s_mov_b64 exec, s[68:69]
    buffer_load_dwordx2 v[106:107], v106, s[8:11], s15 offen offset:1536
    s_mov_b64 exec, -1
    v_mov_b32_dpp v109, v8 row_newbcast:3 row_mask:0xf bank_mask:0xf
    v_mov_b32_dpp v111, v8 row_newbcast:4 row_mask:0xf bank_mask:0xf
    v_cmp_ge_u32 vcc, v109, v2
    v_cmp_ge_u32 s[68:69], v111, v2
    v_and_b32 v108, 0x7f, v89
    v_and_b32 v110, 0x7f, v90
    v_lshl_add_u32 v108, v108, 3, v3
    v_lshl_add_u32 v110, v110, 3, v3
    v_cndmask_b32 v89, -1, v89, vcc
    v_cndmask_b32 v90, -1, v90, s[68:69]
    s_mov_b64 exec, vcc
    buffer_load_dwordx2 v[108:109], v108, s[8:11], s15 offen offset:2304
    s_mov_b64 exec, s[68:69]
    buffer_load_dwordx2 v[110:111], v110, s[8:11], s15 offen offset:3072
    s_mov_b64 exec, -1
L_p2_kernel_eg:
    s_cmp_eq_u32 s100, 0
    s_cbranch_scc1 L_p2_kernel_b5
    s_call_b64 s[24:25], L_p2_kernel_bin5
L_p2_kernel_b5:
    ds_add_u32 v9, v6 offset:0
L_p2_kernel_b0:
    v_cmp_lt_u32_sdwa vcc, s97, v13 src0_sel:DWORD src1_sel:WORD_1
    s_and_b64 s[30:31], vcc, s[34:35]
    s_cbranch_scc0 L_p2_kernel_lga
    s_call_b64 s[24:25], L_p2_kernel_long
L_p2_kernel_lga:
    s_add_u32 s16, s16, 320000
    s_cmp_eq_u32 s19, 0
    s_cbranch_scc1 L_p2_kernel_l1
    s_lshl2_add_u32 s13, s23, -4
    v_add_lshl_u32 v14, v5, s13, 1
    v_add_u32 v16, 792, v4
    s_min_u32 s22, s12, 54
    s_lshl_b32 s22, s22, 2
    s_mov_b32 s12, 0
    s_add_u32 s32, s90, 64
    s_branch L_p2_kernel_aw3_a
L_p2_kernel_aw3:
    s_sleep 10
L_p2_kernel_aw3_a:
    ds_read_b32 v126, v9 offset:0
    s_waitcnt lgkmcnt(0)
    v_readfirstlane_b32 s13, v126
    s_cmp_lt_u32 s13, s32
    s_cbranch_scc1 L_p2_kernel_aw3
L_p2_kernel_aw3_x:
    ds_read_b32 v8, v7
    ds_write_b32 v7, v64
    ds_read2_b32 v[86:87], v16 offset0:198 offset1:165
    ds_read2_b32 v[88:89], v16 offset0:132 offset1:99
    ds_read2_b32 v[90:91], v16 offset0:66 offset1:33
    ds_read2_b32 v[92:93], v4 offset0:198 offset1:165
    ds_read2_b32 v[94:95], v4 offset0:132 offset1:99
    ds_read2_b32 v[96:97], v4 offset0:66 offset1:33
    ds_read_b32 v98, v4
    ds_read_b64 v[14:15], v14
    ds_add_u32 v9, v6 offset:4
    s_add_u32 s90, s90, 64
    s_waitcnt lgkmcnt(1)
    v_sub_u32 v69, 161784, v15
    v_mov_b32 v99, v14
    v_mul_u32_u24 v69, 192, v69
    s_cmp_lt_u32 s17, 5
    s_cbranch_scc1 L_p2_kernel_gr
    s_branch L_p2_kernel_last
L_p2_kernel_l1:
    s_cmp_lg_u32 s17, 1
    s_cbranch_scc1 L_p2_kernel_gr
    s_cmp_lt_u32 s17, 5
    s_cselect_b32 s13, -1, 0
    s_add_u32 s17, s17, 1
    v_and_b32 v13, s13, v10
    v_mov_b32 v10, v11
    v_mov_b32 v11, v12
    v_mov_b32_dpp v12, v13 quad_perm:[1,0,3,2] row_mask:0xf bank_mask:0xf
    v_mov_b32_dpp v52, v13 quad_perm:[0,0,2,2] row_mask:0xf bank_mask:0xf
    v_min_u32_sdwa v126, 8, v13 dst_sel:DWORD dst_unused:UNUSED_PAD src0_sel:DWORD src1_sel:WORD_1
    v_subrev_u32_sdwa v53, v58, v52 dst_sel:DWORD dst_unused:UNUSED_PAD src0_sel:DWORD src1_sel:WORD_1
    v_lshlrev_b32_sdwa v52, 4, v52 dst_sel:DWORD dst_unused:UNUSED_PAD src0_sel:DWORD src1_sel:WORD_0
    v_cmp_lt_i32 vcc, 0, v53
    v_add_u32 v126, -1, v126
    v_min_i32 v53, 4, v53
    v_lshl_add_u32 v70, v126, 27, v52
    v_mbcnt_lo_u32_b32 v126, vcc_lo, 0
    v_add_u32 v52, v52, v56
    v_mbcnt_hi_u32_b32 v126, vcc_hi, v126
    s_bcnt1_i32_b64 s13, vcc
    v_lshl_add_u32 v52, v53, 27, v52
    s_mov_b32 s97, 16
    v_lshlrev_b32 v126, 4, v126
    s_cmp_le_u32 s13, 16
    s_cbranch_scc1 L_p2_kernel_nc4
    s_call_b64 s[20:21], L_p2_kernel_six
L_p2_kernel_nc4:
    v_cndmask_b32 v126, 4, v126, vcc
    ds_permute_b32 v59, v126, v52
    v_add_u32_dpp v126, v70, v1 row_newbcast:0 row_mask:0xf bank_mask:0xf
    v_mov_b32 v32, 0
    s_nop 0
    v_add_u32_dpp v126, v70, v1 row_newbcast:2 row_mask:0xf bank_mask:0xc
    v_cmp_le_i32 vcc, 0, v126
    v_and_b32 v126, 0x87ffffff, v126
    s_mov_b64 exec, vcc
    buffer_load_dwordx4 v[32:35], v126, s[4:7], s72 offen
    s_mov_b64 exec, -1
    v_add_u32_dpp v126, v70, v1 row_newbcast:4 row_mask:0xf bank_mask:0xf
    v_mov_b32 v36, 0
    s_nop 0
    v_add_u32_dpp v126, v70, v1 row_newbcast:6 row_mask:0xf bank_mask:0xc
    v_cmp_le_i32 vcc, 0, v126
    v_and_b32 v126, 0x87ffffff, v126
    s_mov_b64 exec, vcc
    buffer_load_dwordx4 v[36:39], v126, s[4:7], s73 offen
    s_mov_b64 exec, -1
    v_add_u32_dpp v126, v70, v1 row_newbcast:8 row_mask:0xf bank_mask:0xf
    v_mov_b32 v40, 0
    s_nop 0
    v_add_u32_dpp v126, v70, v1 row_newbcast:10 row_mask:0xf bank_mask:0xc
    v_cmp_le_i32 vcc, 0, v126
    v_and_b32 v126, 0x87ffffff, v126
    s_mov_b64 exec, vcc
    buffer_load_dwordx4 v[40:43], v126, s[4:7], s74 offen
    s_mov_b64 exec, -1
    v_add_u32_dpp v126, v70, v1 row_newbcast:12 row_mask:0xf bank_mask:0xf
    v_mov_b32 v44, 0
    s_nop 0
    v_add_u32_dpp v126, v70, v1 row_newbcast:14 row_mask:0xf bank_mask:0xc
    v_cmp_le_i32 vcc, 0, v126
    v_and_b32 v126, 0x87ffffff, v126
    s_mov_b64 exec, vcc
    buffer_load_dwordx4 v[44:47], v126, s[4:7], s75 offen
    s_mov_b64 exec, -1
    s_waitcnt lgkmcnt(0)
    v_add_u32_dpp v126, v59, v57 quad_perm:[0,0,0,0] row_mask:0xf bank_mask:0xf
    v_mov_b32 v48, 0
    v_cmp_le_i32 vcc, 0, v126
    v_and_b32 v126, 0x87ffffff, v126
    s_mov_b64 exec, vcc
    buffer_load_dwordx4 v[48:51], v126, s[4:7], 0 offen
    s_mov_b64 exec, -1
    ds_read2_b32 v[54:55], v9 offset0:0 offset1:1
    s_waitcnt lgkmcnt(0)
    s_branch L_p2_kernel_l2
L_p2_kernel_gr:
    s_setprio 0
    s_cmp_lt_u32 s14, 4
    s_cbranch_scc1 L_p2_kernel_pr2
    s_setprio 0
    s_cmp_lt_u32 s14, 8
    s_cbranch_scc1 L_p2_kernel_pr2
    s_setprio 1
    s_cmp_lt_u32 s14, 12
    s_cbranch_scc1 L_p2_kernel_pr2
    s_setprio 1
L_p2_kernel_pr2:
    s_cmp_eq_u32 s19, 0
    s_cbranch_scc1 L_p2_kernel_gh
    s_add_u32 s18, s15, 3840
    s_add_u32 s29, s15, 7680
    v_mov_b32_dpp v103, v8 row_newbcast:0 row_mask:0xf bank_mask:0xf
    v_cmp_ge_u32 vcc, s22, v5
    v_cmp_ge_u32 s[68:69], v103, v2
    v_and_b32 v100, 0x7f, v99
    v_and_b32 v102, 0x7f, v86
    v_lshl_add_u32 v100, v100, 3, v69
    v_lshl_add_u32 v102, v102, 3, v3
    v_cndmask_b32 v99, -1, v99, vcc
    v_cndmask_b32 v86, -1, v86, s[68:69]
    s_mov_b64 exec, vcc
    buffer_load_dwordx2 v[100:101], v100, s[8:11], s15 offen offset:0
    s_mov_b64 exec, s[68:69]
    buffer_load_dwordx2 v[102:103], v102, s[8:11], s15 offen offset:0
    s_mov_b64 exec, -1
    v_mov_b32_dpp v105, v8 row_newbcast:1 row_mask:0xf bank_mask:0xf
    v_mov_b32_dpp v107, v8 row_newbcast:2 row_mask:0xf bank_mask:0xf
    v_cmp_ge_u32 vcc, v105, v2
    v_cmp_ge_u32 s[68:69], v107, v2
    v_and_b32 v104, 0x7f, v87
    v_and_b32 v106, 0x7f, v88
    v_lshl_add_u32 v104, v104, 3, v3
    v_lshl_add_u32 v106, v106, 3, v3
    v_cndmask_b32 v87, -1, v87, vcc
    v_cndmask_b32 v88, -1, v88, s[68:69]
    s_mov_b64 exec, vcc
    buffer_load_dwordx2 v[104:105], v104, s[8:11], s15 offen offset:768
    s_mov_b64 exec, s[68:69]
    buffer_load_dwordx2 v[106:107], v106, s[8:11], s15 offen offset:1536
    s_mov_b64 exec, -1
    v_mov_b32_dpp v109, v8 row_newbcast:3 row_mask:0xf bank_mask:0xf
    v_mov_b32_dpp v111, v8 row_newbcast:4 row_mask:0xf bank_mask:0xf
    v_cmp_ge_u32 vcc, v109, v2
    v_cmp_ge_u32 s[68:69], v111, v2
    v_and_b32 v108, 0x7f, v89
    v_and_b32 v110, 0x7f, v90
    v_lshl_add_u32 v108, v108, 3, v3
    v_lshl_add_u32 v110, v110, 3, v3
    v_cndmask_b32 v89, -1, v89, vcc
    v_cndmask_b32 v90, -1, v90, s[68:69]
    s_mov_b64 exec, vcc
    buffer_load_dwordx2 v[108:109], v108, s[8:11], s15 offen offset:2304
    s_mov_b64 exec, s[68:69]
    buffer_load_dwordx2 v[110:111], v110, s[8:11], s15 offen offset:3072
    s_mov_b64 exec, -1
L_p2_kernel_gh:
    v_ashrrev_i32 v71, 2, v99
    v_lshrrev_b32 v99, 4, v99
    v_and_b32 v99, 0x1fff8, v99
    v_ashrrev_i32 v84, 2, v86
    v_lshrrev_b32 v86, 4, v86
    v_and_b32 v86, 0x1fff8, v86
    s_waitcnt vmcnt(4)
    ds_read_b64 v[80:81], v99 offset:61968
    ds_read_b64 v[82:83], v86 offset:61968
    v_mfma_f32_4x4x4_16b_bf16 v[14:17], v[120:121], v[100:101], 0
    v_mfma_f32_4x4x4_16b_bf16 v[18:21], v[120:121], v[102:103], 0
    v_and_b32 v71, 0x9ff80000, v71
    v_and_b32 v84, 0x9ff80000, v84
    s_nop 1
    v_cvt_pk_f16_f32 v22, v14, v15
    v_cvt_pk_f16_f32 v23, v16, v17
    v_cvt_pk_f16_f32 v24, v18, v19
    v_cvt_pk_f16_f32 v25, v20, v21
    s_waitcnt lgkmcnt(1)
    v_pk_fma_f16 v22, v22, v71, v80 op_sel:[0,1,0] op_sel_hi:[1,1,1]
    v_pk_fma_f16 v23, v23, v71, v81 op_sel:[0,1,0] op_sel_hi:[1,1,1]
    ds_wrxchg_rtn_b64 v[72:73], v99, v[22:23] offset:61968
    s_waitcnt lgkmcnt(1)
    v_pk_fma_f16 v24, v24, v84, v82 op_sel:[0,1,0] op_sel_hi:[1,1,1]
    v_pk_fma_f16 v25, v25, v84, v83 op_sel:[0,1,0] op_sel_hi:[1,1,1]
    ds_wrxchg_rtn_b64 v[74:75], v86, v[24:25] offset:61968
    v_mov_b32_dpp v101, v8 row_newbcast:5 row_mask:0xf bank_mask:0xf
    v_mov_b32_dpp v103, v8 row_newbcast:6 row_mask:0xf bank_mask:0xf
    v_cmp_ge_u32 vcc, v101, v2
    v_cmp_ge_u32 s[68:69], v103, v2
    v_and_b32 v100, 0x7f, v91
    v_and_b32 v102, 0x7f, v92
    v_lshl_add_u32 v100, v100, 3, v3
    v_lshl_add_u32 v102, v102, 3, v3
    v_cndmask_b32 v91, -1, v91, vcc
    v_cndmask_b32 v92, -1, v92, s[68:69]
    s_mov_b64 exec, vcc
    buffer_load_dwordx2 v[100:101], v100, s[8:11], s18 offen offset:0
    s_mov_b64 exec, s[68:69]
    buffer_load_dwordx2 v[102:103], v102, s[8:11], s18 offen offset:768
    s_mov_b64 exec, -1
    v_ashrrev_i32 v71, 2, v87
    v_lshrrev_b32 v87, 4, v87
    v_and_b32 v87, 0x1fff8, v87
    v_ashrrev_i32 v84, 2, v88
    v_lshrrev_b32 v88, 4, v88
    v_and_b32 v88, 0x1fff8, v88
    s_waitcnt vmcnt(4)
    ds_read_b64 v[116:117], v87 offset:61968
    ds_read_b64 v[118:119], v88 offset:61968
    v_mfma_f32_4x4x4_16b_bf16 v[14:17], v[120:121], v[104:105], 0
    v_mfma_f32_4x4x4_16b_bf16 v[18:21], v[120:121], v[106:107], 0
    v_and_b32 v71, 0x9ff80000, v71
    v_and_b32 v84, 0x9ff80000, v84
    s_nop 1
    v_cvt_pk_f16_f32 v22, v14, v15
    v_cvt_pk_f16_f32 v23, v16, v17
    v_cvt_pk_f16_f32 v24, v18, v19
    v_cvt_pk_f16_f32 v25, v20, v21
    s_waitcnt lgkmcnt(1)
    v_pk_fma_f16 v22, v22, v71, v116 op_sel:[0,1,0] op_sel_hi:[1,1,1]
    v_pk_fma_f16 v23, v23, v71, v117 op_sel:[0,1,0] op_sel_hi:[1,1,1]
    ds_wrxchg_rtn_b64 v[76:77], v87, v[22:23] offset:61968
    s_waitcnt lgkmcnt(1)
    v_pk_fma_f16 v24, v24, v84, v118 op_sel:[0,1,0] op_sel_hi:[1,1,1]
    v_pk_fma_f16 v25, v25, v84, v119 op_sel:[0,1,0] op_sel_hi:[1,1,1]
    ds_wrxchg_rtn_b64 v[78:79], v88, v[24:25] offset:61968
    v_mov_b32_dpp v105, v8 row_newbcast:7 row_mask:0xf bank_mask:0xf
    v_mov_b32_dpp v107, v8 row_newbcast:8 row_mask:0xf bank_mask:0xf
    v_cmp_ge_u32 vcc, v105, v2
    v_cmp_ge_u32 s[68:69], v107, v2
    v_and_b32 v104, 0x7f, v93
    v_and_b32 v106, 0x7f, v94
    v_lshl_add_u32 v104, v104, 3, v3
    v_lshl_add_u32 v106, v106, 3, v3
    v_cndmask_b32 v93, -1, v93, vcc
    v_cndmask_b32 v94, -1, v94, s[68:69]
    s_mov_b64 exec, vcc
    buffer_load_dwordx2 v[104:105], v104, s[8:11], s18 offen offset:1536
    s_mov_b64 exec, s[68:69]
    buffer_load_dwordx2 v[106:107], v106, s[8:11], s18 offen offset:2304
    s_mov_b64 exec, -1
    v_cmp_ne_u64 vcc, v[72:73], v[80:81]
    s_cbranch_vccz L_p2_kernel_fx0
    s_andn2_b64 exec, vcc, s[82:83]
    v_pk_add_f16 v28, v72, v80 neg_lo:[0,1] neg_hi:[0,1]
    v_pk_add_f16 v29, v73, v81 neg_lo:[0,1] neg_hi:[0,1]
    v_mov_b32 v30, v99
    s_and_b64 exec, vcc, s[82:83]
    s_cbranch_scc0 L_p2_kernel_fx0_n
    v_pk_add_f16 v26, v72, v80 neg_lo:[0,1] neg_hi:[0,1]
    v_pk_add_f16 v27, v73, v81 neg_lo:[0,1] neg_hi:[0,1]
    ds_pk_add_f16 v99, v26 offset:61968
    ds_pk_add_f16 v99, v27 offset:61972
L_p2_kernel_fx0_n:
    s_or_b64 s[82:83], s[82:83], vcc
    s_mov_b64 exec, -1
L_p2_kernel_fx0:
    v_cmp_ne_u64 vcc, v[74:75], v[82:83]
    s_cbranch_vccz L_p2_kernel_fx1
    s_andn2_b64 exec, vcc, s[82:83]
    v_pk_add_f16 v28, v74, v82 neg_lo:[0,1] neg_hi:[0,1]
    v_pk_add_f16 v29, v75, v83 neg_lo:[0,1] neg_hi:[0,1]
    v_mov_b32 v30, v86
    s_and_b64 exec, vcc, s[82:83]
    s_cbranch_scc0 L_p2_kernel_fx1_n
    v_pk_add_f16 v26, v74, v82 neg_lo:[0,1] neg_hi:[0,1]
    v_pk_add_f16 v27, v75, v83 neg_lo:[0,1] neg_hi:[0,1]
    ds_pk_add_f16 v86, v26 offset:61968
    ds_pk_add_f16 v86, v27 offset:61972
L_p2_kernel_fx1_n:
    s_or_b64 s[82:83], s[82:83], vcc
    s_mov_b64 exec, -1
L_p2_kernel_fx1:
    s_setprio 1
    s_cmp_lt_u32 s14, 4
    s_cbranch_scc1 L_p2_kernel_pr3
    s_setprio 1
    s_cmp_lt_u32 s14, 8
    s_cbranch_scc1 L_p2_kernel_pr3
    s_setprio 2
    s_cmp_lt_u32 s14, 12
    s_cbranch_scc1 L_p2_kernel_pr3
    s_setprio 3
L_p2_kernel_pr3:
    v_ashrrev_i32 v71, 2, v89
    v_lshrrev_b32 v89, 4, v89
    v_and_b32 v89, 0x1fff8, v89
    v_ashrrev_i32 v84, 2, v90
    v_lshrrev_b32 v90, 4, v90
    v_and_b32 v90, 0x1fff8, v90
    s_waitcnt vmcnt(4)
    ds_read_b64 v[80:81], v89 offset:61968
    ds_read_b64 v[82:83], v90 offset:61968
    v_mfma_f32_4x4x4_16b_bf16 v[14:17], v[120:121], v[108:109], 0
    v_mfma_f32_4x4x4_16b_bf16 v[18:21], v[120:121], v[110:111], 0
    v_and_b32 v71, 0x9ff80000, v71
    v_and_b32 v84, 0x9ff80000, v84
    s_nop 1
    v_cvt_pk_f16_f32 v22, v14, v15
    v_cvt_pk_f16_f32 v23, v16, v17
    v_cvt_pk_f16_f32 v24, v18, v19
    v_cvt_pk_f16_f32 v25, v20, v21
    s_waitcnt lgkmcnt(1)
    v_pk_fma_f16 v22, v22, v71, v80 op_sel:[0,1,0] op_sel_hi:[1,1,1]
    v_pk_fma_f16 v23, v23, v71, v81 op_sel:[0,1,0] op_sel_hi:[1,1,1]
    ds_wrxchg_rtn_b64 v[72:73], v89, v[22:23] offset:61968
    s_waitcnt lgkmcnt(1)
    v_pk_fma_f16 v24, v24, v84, v82 op_sel:[0,1,0] op_sel_hi:[1,1,1]
    v_pk_fma_f16 v25, v25, v84, v83 op_sel:[0,1,0] op_sel_hi:[1,1,1]
    ds_wrxchg_rtn_b64 v[74:75], v90, v[24:25] offset:61968
    v_mov_b32_dpp v109, v8 row_newbcast:9 row_mask:0xf bank_mask:0xf
    v_mov_b32_dpp v111, v8 row_newbcast:10 row_mask:0xf bank_mask:0xf
    v_cmp_ge_u32 vcc, v109, v2
    v_cmp_ge_u32 s[68:69], v111, v2
    v_and_b32 v108, 0x7f, v95
    v_and_b32 v110, 0x7f, v96
    v_lshl_add_u32 v108, v108, 3, v3
    v_lshl_add_u32 v110, v110, 3, v3
    v_cndmask_b32 v95, -1, v95, vcc
    v_cndmask_b32 v96, -1, v96, s[68:69]
    s_mov_b64 exec, vcc
    buffer_load_dwordx2 v[108:109], v108, s[8:11], s18 offen offset:3072
    s_mov_b64 exec, s[68:69]
    buffer_load_dwordx2 v[110:111], v110, s[8:11], s29 offen offset:0
    s_mov_b64 exec, -1
    v_cmp_ne_u64 vcc, v[76:77], v[116:117]
    s_cbranch_vccz L_p2_kernel_fx2
    s_andn2_b64 exec, vcc, s[82:83]
    v_pk_add_f16 v28, v76, v116 neg_lo:[0,1] neg_hi:[0,1]
    v_pk_add_f16 v29, v77, v117 neg_lo:[0,1] neg_hi:[0,1]
    v_mov_b32 v30, v87
    s_and_b64 exec, vcc, s[82:83]
    s_cbranch_scc0 L_p2_kernel_fx2_n
    v_pk_add_f16 v26, v76, v116 neg_lo:[0,1] neg_hi:[0,1]
    v_pk_add_f16 v27, v77, v117 neg_lo:[0,1] neg_hi:[0,1]
    ds_pk_add_f16 v87, v26 offset:61968
    ds_pk_add_f16 v87, v27 offset:61972
L_p2_kernel_fx2_n:
    s_or_b64 s[82:83], s[82:83], vcc
    s_mov_b64 exec, -1
L_p2_kernel_fx2:
    v_cmp_ne_u64 vcc, v[78:79], v[118:119]
    s_cbranch_vccz L_p2_kernel_fx3
    s_andn2_b64 exec, vcc, s[82:83]
    v_pk_add_f16 v28, v78, v118 neg_lo:[0,1] neg_hi:[0,1]
    v_pk_add_f16 v29, v79, v119 neg_lo:[0,1] neg_hi:[0,1]
    v_mov_b32 v30, v88
    s_and_b64 exec, vcc, s[82:83]
    s_cbranch_scc0 L_p2_kernel_fx3_n
    v_pk_add_f16 v26, v78, v118 neg_lo:[0,1] neg_hi:[0,1]
    v_pk_add_f16 v27, v79, v119 neg_lo:[0,1] neg_hi:[0,1]
    ds_pk_add_f16 v88, v26 offset:61968
    ds_pk_add_f16 v88, v27 offset:61972
L_p2_kernel_fx3_n:
    s_or_b64 s[82:83], s[82:83], vcc
    s_mov_b64 exec, -1
L_p2_kernel_fx3:
    v_ashrrev_i32 v71, 2, v91
    v_lshrrev_b32 v91, 4, v91
    v_and_b32 v91, 0x1fff8, v91
    v_ashrrev_i32 v84, 2, v92
    v_lshrrev_b32 v92, 4, v92
    v_and_b32 v92, 0x1fff8, v92
    s_waitcnt vmcnt(4)
    ds_read_b64 v[116:117], v91 offset:61968
    ds_read_b64 v[118:119], v92 offset:61968
    ds_read_b64 v[112:113], v30 offset:61968
    v_mfma_f32_4x4x4_16b_bf16 v[14:17], v[120:121], v[100:101], 0
    v_mfma_f32_4x4x4_16b_bf16 v[18:21], v[120:121], v[102:103], 0
    v_and_b32 v71, 0x9ff80000, v71
    v_and_b32 v84, 0x9ff80000, v84
    s_nop 1
    v_cvt_pk_f16_f32 v22, v14, v15
    v_cvt_pk_f16_f32 v23, v16, v17
    v_cvt_pk_f16_f32 v24, v18, v19
    v_cvt_pk_f16_f32 v25, v20, v21
    s_waitcnt lgkmcnt(2)
    v_pk_fma_f16 v22, v22, v71, v116 op_sel:[0,1,0] op_sel_hi:[1,1,1]
    v_pk_fma_f16 v23, v23, v71, v117 op_sel:[0,1,0] op_sel_hi:[1,1,1]
    ds_wrxchg_rtn_b64 v[76:77], v91, v[22:23] offset:61968
    s_waitcnt lgkmcnt(2)
    v_pk_fma_f16 v24, v24, v84, v118 op_sel:[0,1,0] op_sel_hi:[1,1,1]
    v_pk_fma_f16 v25, v25, v84, v119 op_sel:[0,1,0] op_sel_hi:[1,1,1]
    ds_wrxchg_rtn_b64 v[78:79], v92, v[24:25] offset:61968
    s_waitcnt lgkmcnt(2)
    v_pk_add_f16 v28, v28, v112
    v_pk_add_f16 v29, v29, v113
    v_mov_b32 v31, v30
    ds_wrxchg_rtn_b64 v[114:115], v30, v[28:29] offset:61968
    v_mov_b32 v30, 0x1fff8
    s_mov_b64 s[82:83], 0
    v_mov_b32_dpp v101, v8 row_newbcast:11 row_mask:0xf bank_mask:0xf
    v_mov_b32_dpp v103, v8 row_newbcast:12 row_mask:0xf bank_mask:0xf
    v_cmp_ge_u32 vcc, v101, v2
    v_cmp_ge_u32 s[68:69], v103, v2
    v_and_b32 v100, 0x7f, v97
    v_and_b32 v102, 0x7f, v98
    v_lshl_add_u32 v100, v100, 3, v3
    v_lshl_add_u32 v102, v102, 3, v3
    v_cndmask_b32 v97, -1, v97, vcc
    v_cndmask_b32 v98, -1, v98, s[68:69]
    s_mov_b64 exec, vcc
    buffer_load_dwordx2 v[100:101], v100, s[8:11], s29 offen offset:768
    s_mov_b64 exec, s[68:69]
    buffer_load_dwordx2 v[102:103], v102, s[8:11], s29 offen offset:1536
    s_mov_b64 exec, -1
    s_cmp_lt_u32 s17, 5
    s_cselect_b32 s13, -1, 0
    s_add_u32 s17, s17, 1
    v_and_b32 v13, s13, v10
    v_mov_b32 v10, v11
    v_mov_b32 v11, v12
    v_mov_b32_dpp v12, v13 quad_perm:[1,0,3,2] row_mask:0xf bank_mask:0xf
    v_mov_b32_dpp v52, v13 quad_perm:[0,0,2,2] row_mask:0xf bank_mask:0xf
    v_min_u32_sdwa v126, 8, v13 dst_sel:DWORD dst_unused:UNUSED_PAD src0_sel:DWORD src1_sel:WORD_1
    v_subrev_u32_sdwa v53, v58, v52 dst_sel:DWORD dst_unused:UNUSED_PAD src0_sel:DWORD src1_sel:WORD_1
    v_lshlrev_b32_sdwa v52, 4, v52 dst_sel:DWORD dst_unused:UNUSED_PAD src0_sel:DWORD src1_sel:WORD_0
    v_cmp_lt_i32 vcc, 0, v53
    v_add_u32 v126, -1, v126
    v_min_i32 v53, 4, v53
    v_lshl_add_u32 v70, v126, 27, v52
    v_mbcnt_lo_u32_b32 v126, vcc_lo, 0
    v_add_u32 v52, v52, v56
    v_mbcnt_hi_u32_b32 v126, vcc_hi, v126
    s_bcnt1_i32_b64 s13, vcc
    v_lshl_add_u32 v52, v53, 27, v52
    s_mov_b32 s97, 16
    v_lshlrev_b32 v126, 4, v126
    s_cmp_le_u32 s13, 16
    s_cbranch_scc1 L_p2_kernel_nc5
    s_call_b64 s[20:21], L_p2_kernel_six
L_p2_kernel_nc5:
    v_cndmask_b32 v126, 4, v126, vcc
    ds_permute_b32 v59, v126, v52
    v_add_u32_dpp v126, v70, v1 row_newbcast:0 row_mask:0xf bank_mask:0xf
    v_mov_b32 v32, 0
    s_nop 0
    v_add_u32_dpp v126, v70, v1 row_newbcast:2 row_mask:0xf bank_mask:0xc
    v_cmp_le_i32 vcc, 0, v126
    v_and_b32 v126, 0x87ffffff, v126
    s_mov_b64 exec, vcc
    buffer_load_dwordx4 v[32:35], v126, s[4:7], s72 offen
    s_mov_b64 exec, -1
    v_cmp_ne_u64 vcc, v[72:73], v[80:81]
    s_cbranch_vccz L_p2_kernel_fx4
    s_andn2_b64 exec, vcc, s[82:83]
    v_pk_add_f16 v28, v72, v80 neg_lo:[0,1] neg_hi:[0,1]
    v_pk_add_f16 v29, v73, v81 neg_lo:[0,1] neg_hi:[0,1]
    v_mov_b32 v30, v89
    s_and_b64 exec, vcc, s[82:83]
    s_cbranch_scc0 L_p2_kernel_fx4_n
    v_pk_add_f16 v26, v72, v80 neg_lo:[0,1] neg_hi:[0,1]
    v_pk_add_f16 v27, v73, v81 neg_lo:[0,1] neg_hi:[0,1]
    ds_pk_add_f16 v89, v26 offset:61968
    ds_pk_add_f16 v89, v27 offset:61972
L_p2_kernel_fx4_n:
    s_or_b64 s[82:83], s[82:83], vcc
    s_mov_b64 exec, -1
L_p2_kernel_fx4:
    v_cmp_ne_u64 vcc, v[74:75], v[82:83]
    s_cbranch_vccz L_p2_kernel_fx5
    s_andn2_b64 exec, vcc, s[82:83]
    v_pk_add_f16 v28, v74, v82 neg_lo:[0,1] neg_hi:[0,1]
    v_pk_add_f16 v29, v75, v83 neg_lo:[0,1] neg_hi:[0,1]
    v_mov_b32 v30, v90
    s_and_b64 exec, vcc, s[82:83]
    s_cbranch_scc0 L_p2_kernel_fx5_n
    v_pk_add_f16 v26, v74, v82 neg_lo:[0,1] neg_hi:[0,1]
    v_pk_add_f16 v27, v75, v83 neg_lo:[0,1] neg_hi:[0,1]
    ds_pk_add_f16 v90, v26 offset:61968
    ds_pk_add_f16 v90, v27 offset:61972
L_p2_kernel_fx5_n:
    s_or_b64 s[82:83], s[82:83], vcc
    s_mov_b64 exec, -1
L_p2_kernel_fx5:
    v_ashrrev_i32 v71, 2, v93
    v_lshrrev_b32 v93, 4, v93
    v_and_b32 v93, 0x1fff8, v93
    v_ashrrev_i32 v84, 2, v94
    v_lshrrev_b32 v94, 4, v94
    v_and_b32 v94, 0x1fff8, v94
    s_waitcnt vmcnt(5)
    ds_read_b64 v[80:81], v93 offset:61968
    ds_read_b64 v[82:83], v94 offset:61968
    v_mfma_f32_4x4x4_16b_bf16 v[14:17], v[120:121], v[104:105], 0
    v_mfma_f32_4x4x4_16b_bf16 v[18:21], v[120:121], v[106:107], 0
    v_and_b32 v71, 0x9ff80000, v71
    v_and_b32 v84, 0x9ff80000, v84
    s_nop 1
    v_cvt_pk_f16_f32 v22, v14, v15
    v_cvt_pk_f16_f32 v23, v16, v17
    v_cvt_pk_f16_f32 v24, v18, v19
    v_cvt_pk_f16_f32 v25, v20, v21
    s_waitcnt lgkmcnt(1)
    v_pk_fma_f16 v22, v22, v71, v80 op_sel:[0,1,0] op_sel_hi:[1,1,1]
    v_pk_fma_f16 v23, v23, v71, v81 op_sel:[0,1,0] op_sel_hi:[1,1,1]
    ds_wrxchg_rtn_b64 v[72:73], v93, v[22:23] offset:61968
    s_waitcnt lgkmcnt(1)
    v_pk_fma_f16 v24, v24, v84, v82 op_sel:[0,1,0] op_sel_hi:[1,1,1]
    v_pk_fma_f16 v25, v25, v84, v83 op_sel:[0,1,0] op_sel_hi:[1,1,1]
    ds_wrxchg_rtn_b64 v[74:75], v94, v[24:25] offset:61968
    v_add_u32_dpp v126, v70, v1 row_newbcast:4 row_mask:0xf bank_mask:0xf
    v_mov_b32 v36, 0
    s_nop 0
    v_add_u32_dpp v126, v70, v1 row_newbcast:6 row_mask:0xf bank_mask:0xc
    v_cmp_le_i32 vcc, 0, v126
    v_and_b32 v126, 0x87ffffff, v126
    s_mov_b64 exec, vcc
    buffer_load_dwordx4 v[36:39], v126, s[4:7], s73 offen
    s_mov_b64 exec, -1
    v_cmp_ne_u64 vcc, v[76:77], v[116:117]
    s_cbranch_vccz L_p2_kernel_fx6
    s_andn2_b64 exec, vcc, s[82:83]
    v_pk_add_f16 v28, v76, v116 neg_lo:[0,1] neg_hi:[0,1]
    v_pk_add_f16 v29, v77, v117 neg_lo:[0,1] neg_hi:[0,1]
    v_mov_b32 v30, v91
    s_and_b64 exec, vcc, s[82:83]
    s_cbranch_scc0 L_p2_kernel_fx6_n
    v_pk_add_f16 v26, v76, v116 neg_lo:[0,1] neg_hi:[0,1]
    v_pk_add_f16 v27, v77, v117 neg_lo:[0,1] neg_hi:[0,1]
    ds_pk_add_f16 v91, v26 offset:61968
    ds_pk_add_f16 v91, v27 offset:61972
L_p2_kernel_fx6_n:
    s_or_b64 s[82:83], s[82:83], vcc
    s_mov_b64 exec, -1
L_p2_kernel_fx6:
    v_cmp_ne_u64 vcc, v[78:79], v[118:119]
    s_cbranch_vccz L_p2_kernel_fx7
    s_andn2_b64 exec, vcc, s[82:83]
    v_pk_add_f16 v28, v78, v118 neg_lo:[0,1] neg_hi:[0,1]
    v_pk_add_f16 v29, v79, v119 neg_lo:[0,1] neg_hi:[0,1]
    v_mov_b32 v30, v92
    s_and_b64 exec, vcc, s[82:83]
    s_cbranch_scc0 L_p2_kernel_fx7_n
    v_pk_add_f16 v26, v78, v118 neg_lo:[0,1] neg_hi:[0,1]
    v_pk_add_f16 v27, v79, v119 neg_lo:[0,1] neg_hi:[0,1]
    ds_pk_add_f16 v92, v26 offset:61968
    ds_pk_add_f16 v92, v27 offset:61972
L_p2_kernel_fx7_n:
    s_or_b64 s[82:83], s[82:83], vcc
    s_mov_b64 exec, -1
L_p2_kernel_fx7:
    v_cmp_ne_u64 vcc, v[114:115], v[112:113]
    s_cbranch_vccz L_p2_kernel_fl8
    v_pk_add_f16 v26, v114, v112 neg_lo:[0,1] neg_hi:[0,1]
    v_pk_add_f16 v27, v115, v113 neg_lo:[0,1] neg_hi:[0,1]
    s_mov_b64 exec, vcc
    ds_pk_add_f16 v31, v26 offset:61968
    ds_pk_add_f16 v31, v27 offset:61972
    s_mov_b64 exec, -1
L_p2_kernel_fl8:
    v_ashrrev_i32 v71, 2, v95
    v_lshrrev_b32 v95, 4, v95
    v_and_b32 v95, 0x1fff8, v95
    v_ashrrev_i32 v84, 2, v96
    v_lshrrev_b32 v96, 4, v96
    v_and_b32 v96, 0x1fff8, v96
    s_waitcnt vmcnt(4)
    ds_read_b64 v[116:117], v95 offset:61968
    ds_read_b64 v[118:119], v96 offset:61968
    v_mfma_f32_4x4x4_16b_bf16 v[14:17], v[120:121], v[108:109], 0
    v_mfma_f32_4x4x4_16b_bf16 v[18:21], v[120:121], v[110:111], 0
    v_and_b32 v71, 0x9ff80000, v71
    v_and_b32 v84, 0x9ff80000, v84
    s_nop 1
    v_cvt_pk_f16_f32 v22, v14, v15
    v_cvt_pk_f16_f32 v23, v16, v17
    v_cvt_pk_f16_f32 v24, v18, v19
    v_cvt_pk_f16_f32 v25, v20, v21
    s_waitcnt lgkmcnt(1)
    v_pk_fma_f16 v22, v22, v71, v116 op_sel:[0,1,0] op_sel_hi:[1,1,1]
    v_pk_fma_f16 v23, v23, v71, v117 op_sel:[0,1,0] op_sel_hi:[1,1,1]
    ds_wrxchg_rtn_b64 v[76:77], v95, v[22:23] offset:61968
    s_waitcnt lgkmcnt(1)
    v_pk_fma_f16 v24, v24, v84, v118 op_sel:[0,1,0] op_sel_hi:[1,1,1]
    v_pk_fma_f16 v25, v25, v84, v119 op_sel:[0,1,0] op_sel_hi:[1,1,1]
    ds_wrxchg_rtn_b64 v[78:79], v96, v[24:25] offset:61968
    v_add_u32_dpp v126, v70, v1 row_newbcast:8 row_mask:0xf bank_mask:0xf
    v_mov_b32 v40, 0
    s_nop 0
    v_add_u32_dpp v126, v70, v1 row_newbcast:10 row_mask:0xf bank_mask:0xc
    v_cmp_le_i32 vcc, 0, v126
    v_and_b32 v126, 0x87ffffff, v126
    s_mov_b64 exec, vcc
    buffer_load_dwordx4 v[40:43], v126, s[4:7], s74 offen
    s_mov_b64 exec, -1
    v_add_u32_dpp v126, v70, v1 row_newbcast:12 row_mask:0xf bank_mask:0xf
    v_mov_b32 v44, 0
    s_nop 0
    v_add_u32_dpp v126, v70, v1 row_newbcast:14 row_mask:0xf bank_mask:0xc
    v_cmp_le_i32 vcc, 0, v126
    v_and_b32 v126, 0x87ffffff, v126
    s_mov_b64 exec, vcc
    buffer_load_dwordx4 v[44:47], v126, s[4:7], s75 offen
    s_mov_b64 exec, -1
    v_cmp_ne_u64 vcc, v[72:73], v[80:81]
    s_cbranch_vccz L_p2_kernel_fx8
    s_andn2_b64 exec, vcc, s[82:83]
    v_pk_add_f16 v28, v72, v80 neg_lo:[0,1] neg_hi:[0,1]
    v_pk_add_f16 v29, v73, v81 neg_lo:[0,1] neg_hi:[0,1]
    v_mov_b32 v30, v93
    s_and_b64 exec, vcc, s[82:83]
    s_cbranch_scc0 L_p2_kernel_fx8_n
    v_pk_add_f16 v26, v72, v80 neg_lo:[0,1] neg_hi:[0,1]
    v_pk_add_f16 v27, v73, v81 neg_lo:[0,1] neg_hi:[0,1]
    ds_pk_add_f16 v93, v26 offset:61968
    ds_pk_add_f16 v93, v27 offset:61972
L_p2_kernel_fx8_n:
    s_or_b64 s[82:83], s[82:83], vcc
    s_mov_b64 exec, -1
L_p2_kernel_fx8:
    v_cmp_ne_u64 vcc, v[74:75], v[82:83]
    s_cbranch_vccz L_p2_kernel_fx9
    s_andn2_b64 exec, vcc, s[82:83]
    v_pk_add_f16 v28, v74, v82 neg_lo:[0,1] neg_hi:[0,1]
    v_pk_add_f16 v29, v75, v83 neg_lo:[0,1] neg_hi:[0,1]
    v_mov_b32 v30, v94
    s_and_b64 exec, vcc, s[82:83]
    s_cbranch_scc0 L_p2_kernel_fx9_n
    v_pk_add_f16 v26, v74, v82 neg_lo:[0,1] neg_hi:[0,1]
    v_pk_add_f16 v27, v75, v83 neg_lo:[0,1] neg_hi:[0,1]
    ds_pk_add_f16 v94, v26 offset:61968
    ds_pk_add_f16 v94, v27 offset:61972
L_p2_kernel_fx9_n:
    s_or_b64 s[82:83], s[82:83], vcc
    s_mov_b64 exec, -1
L_p2_kernel_fx9:
    v_ashrrev_i32 v71, 2, v97
    v_lshrrev_b32 v97, 4, v97
    v_and_b32 v97, 0x1fff8, v97
    v_ashrrev_i32 v84, 2, v98
    v_lshrrev_b32 v98, 4, v98
    v_and_b32 v98, 0x1fff8, v98
    s_waitcnt vmcnt(4)
    ds_read_b64 v[80:81], v97 offset:61968
    ds_read_b64 v[82:83], v98 offset:61968
    v_mfma_f32_4x4x4_16b_bf16 v[14:17], v[120:121], v[100:101], 0
    v_mfma_f32_4x4x4_16b_bf16 v[18:21], v[120:121], v[102:103], 0
    v_and_b32 v71, 0x9ff80000, v71
    v_and_b32 v84, 0x9ff80000, v84
    s_nop 1
    v_cvt_pk_f16_f32 v22, v14, v15
    v_cvt_pk_f16_f32 v23, v16, v17
    v_cvt_pk_f16_f32 v24, v18, v19
    v_cvt_pk_f16_f32 v25, v20, v21
    s_waitcnt lgkmcnt(1)
    v_pk_fma_f16 v22, v22, v71, v80 op_sel:[0,1,0] op_sel_hi:[1,1,1]
    v_pk_fma_f16 v23, v23, v71, v81 op_sel:[0,1,0] op_sel_hi:[1,1,1]
    ds_wrxchg_rtn_b64 v[72:73], v97, v[22:23] offset:61968
    s_waitcnt lgkmcnt(1)
    v_pk_fma_f16 v24, v24, v84, v82 op_sel:[0,1,0] op_sel_hi:[1,1,1]
    v_pk_fma_f16 v25, v25, v84, v83 op_sel:[0,1,0] op_sel_hi:[1,1,1]
    ds_wrxchg_rtn_b64 v[74:75], v98, v[24:25] offset:61968
    ds_read2_b32 v[54:55], v9 offset0:0 offset1:1
    v_add_u32_dpp v126, v59, v57 quad_perm:[0,0,0,0] row_mask:0xf bank_mask:0xf
    v_mov_b32 v48, 0
    v_cmp_le_i32 vcc, 0, v126
    v_and_b32 v126, 0x87ffffff, v126
    s_mov_b64 exec, vcc
    buffer_load_dwordx4 v[48:51], v126, s[4:7], 0 offen
    s_mov_b64 exec, -1
    v_cmp_ne_u64 vcc, v[76:77], v[116:117]
    s_cbranch_vccz L_p2_kernel_fx10
    s_andn2_b64 exec, vcc, s[82:83]
    v_pk_add_f16 v28, v76, v116 neg_lo:[0,1] neg_hi:[0,1]
    v_pk_add_f16 v29, v77, v117 neg_lo:[0,1] neg_hi:[0,1]
    v_mov_b32 v30, v95
    s_and_b64 exec, vcc, s[82:83]
    s_cbranch_scc0 L_p2_kernel_fx10_n
    v_pk_add_f16 v26, v76, v116 neg_lo:[0,1] neg_hi:[0,1]
    v_pk_add_f16 v27, v77, v117 neg_lo:[0,1] neg_hi:[0,1]
    ds_pk_add_f16 v95, v26 offset:61968
    ds_pk_add_f16 v95, v27 offset:61972
L_p2_kernel_fx10_n:
    s_or_b64 s[82:83], s[82:83], vcc
    s_mov_b64 exec, -1
L_p2_kernel_fx10:
    v_cmp_ne_u64 vcc, v[78:79], v[118:119]
    s_cbranch_vccz L_p2_kernel_fx11
    s_andn2_b64 exec, vcc, s[82:83]
    v_pk_add_f16 v28, v78, v118 neg_lo:[0,1] neg_hi:[0,1]
    v_pk_add_f16 v29, v79, v119 neg_lo:[0,1] neg_hi:[0,1]
    v_mov_b32 v30, v96
    s_and_b64 exec, vcc, s[82:83]
    s_cbranch_scc0 L_p2_kernel_fx11_n
    v_pk_add_f16 v26, v78, v118 neg_lo:[0,1] neg_hi:[0,1]
    v_pk_add_f16 v27, v79, v119 neg_lo:[0,1] neg_hi:[0,1]
    ds_pk_add_f16 v96, v26 offset:61968
    ds_pk_add_f16 v96, v27 offset:61972
L_p2_kernel_fx11_n:
    s_or_b64 s[82:83], s[82:83], vcc
    s_mov_b64 exec, -1
L_p2_kernel_fx11:
    s_waitcnt lgkmcnt(2)
    v_cmp_ne_u64 vcc, v[72:73], v[80:81]
    s_cbranch_vccz L_p2_kernel_fx12
    s_andn2_b64 exec, vcc, s[82:83]
    v_pk_add_f16 v28, v72, v80 neg_lo:[0,1] neg_hi:[0,1]
    v_pk_add_f16 v29, v73, v81 neg_lo:[0,1] neg_hi:[0,1]
    v_mov_b32 v30, v97
    s_and_b64 exec, vcc, s[82:83]
    s_cbranch_scc0 L_p2_kernel_fx12_n
    v_pk_add_f16 v26, v72, v80 neg_lo:[0,1] neg_hi:[0,1]
    v_pk_add_f16 v27, v73, v81 neg_lo:[0,1] neg_hi:[0,1]
    ds_pk_add_f16 v97, v26 offset:61968
    ds_pk_add_f16 v97, v27 offset:61972
L_p2_kernel_fx12_n:
    s_or_b64 s[82:83], s[82:83], vcc
    s_mov_b64 exec, -1
L_p2_kernel_fx12:
    s_waitcnt lgkmcnt(1)
    v_cmp_ne_u64 vcc, v[74:75], v[82:83]
    s_cbranch_vccz L_p2_kernel_fx13
    s_andn2_b64 exec, vcc, s[82:83]
    v_pk_add_f16 v28, v74, v82 neg_lo:[0,1] neg_hi:[0,1]
    v_pk_add_f16 v29, v75, v83 neg_lo:[0,1] neg_hi:[0,1]
    v_mov_b32 v30, v98
    s_and_b64 exec, vcc, s[82:83]
    s_cbranch_scc0 L_p2_kernel_fx13_n
    v_pk_add_f16 v26, v74, v82 neg_lo:[0,1] neg_hi:[0,1]
    v_pk_add_f16 v27, v75, v83 neg_lo:[0,1] neg_hi:[0,1]
    ds_pk_add_f16 v98, v26 offset:61968
    ds_pk_add_f16 v98, v27 offset:61972
L_p2_kernel_fx13_n:
    s_or_b64 s[82:83], s[82:83], vcc
    s_mov_b64 exec, -1
L_p2_kernel_fx13:
    s_waitcnt lgkmcnt(0)
    s_add_u32 s15, s15, 320000
    s_cmp_eq_u32 s19, 0
    s_cbranch_scc0 L_p2_kernel_loop
L_p2_kernel_l2:
    s_lshl2_add_u32 s13, s23, -4
    v_add_lshl_u32 v14, v5, s13, 1
    v_add_u32 v16, 792, v4
    s_min_u32 s22, s12, 54
    s_lshl_b32 s22, s22, 2
    s_mov_b32 s12, 0
    v_readfirstlane_b32 s13, v54
    s_add_u32 s32, s90, 64
    s_cmp_ge_u32 s13, s32
    s_cbranch_scc1 L_p2_kernel_aw6_x
    s_branch L_p2_kernel_aw6_a
L_p2_kernel_aw6:
    s_sleep 10
L_p2_kernel_aw6_a:
    ds_read_b32 v126, v9 offset:0
    s_waitcnt lgkmcnt(0)
    v_readfirstlane_b32 s13, v126
    s_cmp_lt_u32 s13, s32
    s_cbranch_scc1 L_p2_kernel_aw6
L_p2_kernel_aw6_x:
    ds_read_b32 v8, v7
    ds_write_b32 v7, v64
    ds_read2_b32 v[86:87], v16 offset0:198 offset1:165
    ds_read2_b32 v[88:89], v16 offset0:132 offset1:99
    ds_read2_b32 v[90:91], v16 offset0:66 offset1:33
    ds_read2_b32 v[92:93], v4 offset0:198 offset1:165
    ds_read2_b32 v[94:95], v4 offset0:132 offset1:99
    ds_read2_b32 v[96:97], v4 offset0:66 offset1:33
    ds_read_b32 v98, v4
    ds_read_b64 v[14:15], v14
    ds_add_u32 v9, v6 offset:4
    ds_read2_b32 v[54:55], v9 offset0:0 offset1:1
    s_add_u32 s90, s90, 64
    s_waitcnt lgkmcnt(0)
    v_sub_u32 v69, 161784, v15
    v_mov_b32 v99, v14
    v_mul_u32_u24 v69, 192, v69
    s_cmp_le_u32 s17, 5
    s_cbranch_scc1 L_p2_kernel_loop
L_p2_kernel_last:
    s_setprio 0
    s_add_u32 s18, s15, 3840
    s_add_u32 s29, s15, 7680
    v_mov_b32_dpp v103, v8 row_newbcast:0 row_mask:0xf bank_mask:0xf
    v_cmp_ge_u32 vcc, s22, v5
    v_cmp_ge_u32 s[68:69], v103, v2
    v_and_b32 v100, 0x7f, v99
    v_and_b32 v102, 0x7f, v86
    v_lshl_add_u32 v100, v100, 3, v69
    v_lshl_add_u32 v102, v102, 3, v3
    v_cndmask_b32 v99, -1, v99, vcc
    v_cndmask_b32 v86, -1, v86, s[68:69]
    s_mov_b64 exec, vcc
    buffer_load_dwordx2 v[100:101], v100, s[8:11], s15 offen offset:0
    s_mov_b64 exec, s[68:69]
    buffer_load_dwordx2 v[102:103], v102, s[8:11], s15 offen offset:0
    s_mov_b64 exec, -1
    v_mov_b32_dpp v105, v8 row_newbcast:1 row_mask:0xf bank_mask:0xf
    v_mov_b32_dpp v107, v8 row_newbcast:2 row_mask:0xf bank_mask:0xf
    v_cmp_ge_u32 vcc, v105, v2
    v_cmp_ge_u32 s[68:69], v107, v2
    v_and_b32 v104, 0x7f, v87
    v_and_b32 v106, 0x7f, v88
    v_lshl_add_u32 v104, v104, 3, v3
    v_lshl_add_u32 v106, v106, 3, v3
    v_cndmask_b32 v87, -1, v87, vcc
    v_cndmask_b32 v88, -1, v88, s[68:69]
    s_mov_b64 exec, vcc
    buffer_load_dwordx2 v[104:105], v104, s[8:11], s15 offen offset:768
    s_mov_b64 exec, s[68:69]
    buffer_load_dwordx2 v[106:107], v106, s[8:11], s15 offen offset:1536
    s_mov_b64 exec, -1
    v_mov_b32_dpp v109, v8 row_newbcast:3 row_mask:0xf bank_mask:0xf
    v_mov_b32_dpp v111, v8 row_newbcast:4 row_mask:0xf bank_mask:0xf
    v_cmp_ge_u32 vcc, v109, v2
    v_cmp_ge_u32 s[68:69], v111, v2
    v_and_b32 v108, 0x7f, v89
    v_and_b32 v110, 0x7f, v90
    v_lshl_add_u32 v108, v108, 3, v3
    v_lshl_add_u32 v110, v110, 3, v3
    v_cndmask_b32 v89, -1, v89, vcc
    v_cndmask_b32 v90, -1, v90, s[68:69]
    s_mov_b64 exec, vcc
    buffer_load_dwordx2 v[108:109], v108, s[8:11], s15 offen offset:2304
    s_mov_b64 exec, s[68:69]
    buffer_load_dwordx2 v[110:111], v110, s[8:11], s15 offen offset:3072
    s_mov_b64 exec, -1
    s_bfe_u32 s63, s2, 0x20001
    s_and_b32 s33, s2, 1
    s_lshl_b32 s33, s33, 5
    s_lshr_b32 s13, s2, 3
    s_add_u32 s33, s33, s13
    s_mul_i32 s26, s33, 100096
    s_add_u32 s13, s26, 88080384
    s_add_u32 s48, s98, s13
    s_addc_u32 s49, s99, 0
    s_mov_b32 s50, 19300352
    s_mov_b32 s51, 0x00020000
    s_mul_i32 s13, s63, 6400000
    s_add_u32 s84, s48, s13
    s_addc_u32 s85, s49, 0
    s_sub_u32 s13, 6400000, s26
    s_min_u32 s86, s13, 100096
    s_mov_b32 s87, 0x00020000
    s_add_u32 s44, s8, s26
    s_addc_u32 s45, s9, 0
    s_mov_b32 s46, s86
    s_mov_b32 s47, 0x00020000
    s_add_u32 s40, s40, s26
    s_addc_u32 s41, s41, 0
    s_mov_b32 s42, s86
    s_mov_b32 s43, 0x00020000
    s_lshr_b32 s26, s26, 2
    s_add_u32 s36, s36, s26
    s_addc_u32 s37, s37, 0
    s_lshr_b32 s38, s86, 2
    s_mov_b32 s39, 0x00020000
    s_lshl_b32 s13, s33, 4
    s_add_u32 s13, s13, s14
    s_lshl_b32 s13, s13, 7
    s_add_u32 s13, s13, 87035904
    s_add_u32 s64, s98, s13
    s_addc_u32 s65, s99, 0
    s_movk_i32 s13, 544
    v_cmp_gt_u32 s[66:67], s13, v0
    s_lshl_b32 s52, s92, 16
    s_and_b32 s53, s92, 0xffff0000
    s_lshl_b32 s54, s93, 16
    s_and_b32 s55, s93, 0xffff0000
    s_lshl_b32 s56, s94, 16
    s_and_b32 s57, s94, 0xffff0000
    s_lshl_b32 s58, s95, 16
    s_and_b32 s59, s95, 0xffff0000
L_p2_kernel_e1:
    s_setprio 3
    v_ashrrev_i32 v71, 2, v99
    v_lshrrev_b32 v99, 4, v99
    v_and_b32 v99, 0x1fff8, v99
    v_ashrrev_i32 v84, 2, v86
    v_lshrrev_b32 v86, 4, v86
    v_and_b32 v86, 0x1fff8, v86
    s_waitcnt vmcnt(4)
    ds_read_b64 v[80:81], v99 offset:61968
    ds_read_b64 v[82:83], v86 offset:61968
    v_mfma_f32_4x4x4_16b_bf16 v[14:17], v[120:121], v[100:101], 0
    v_mfma_f32_4x4x4_16b_bf16 v[18:21], v[120:121], v[102:103], 0
    v_and_b32 v71, 0x9ff80000, v71
    v_and_b32 v84, 0x9ff80000, v84
    s_nop 1
    v_cvt_pk_f16_f32 v22, v14, v15
    v_cvt_pk_f16_f32 v23, v16, v17
    v_cvt_pk_f16_f32 v24, v18, v19
    v_cvt_pk_f16_f32 v25, v20, v21
    s_waitcnt lgkmcnt(1)
    v_pk_fma_f16 v22, v22, v71, v80 op_sel:[0,1,0] op_sel_hi:[1,1,1]
    v_pk_fma_f16 v23, v23, v71, v81 op_sel:[0,1,0] op_sel_hi:[1,1,1]
    ds_wrxchg_rtn_b64 v[72:73], v99, v[22:23] offset:61968
    s_waitcnt lgkmcnt(1)
    v_pk_fma_f16 v24, v24, v84, v82 op_sel:[0,1,0] op_sel_hi:[1,1,1]
    v_pk_fma_f16 v25, v25, v84, v83 op_sel:[0,1,0] op_sel_hi:[1,1,1]
    ds_wrxchg_rtn_b64 v[74:75], v86, v[24:25] offset:61968
    v_mov_b32_dpp v101, v8 row_newbcast:5 row_mask:0xf bank_mask:0xf
    v_mov_b32_dpp v103, v8 row_newbcast:6 row_mask:0xf bank_mask:0xf
    v_cmp_ge_u32 vcc, v101, v2
    v_cmp_ge_u32 s[68:69], v103, v2
    v_and_b32 v100, 0x7f, v91
    v_and_b32 v102, 0x7f, v92
    v_lshl_add_u32 v100, v100, 3, v3
    v_lshl_add_u32 v102, v102, 3, v3
    v_cndmask_b32 v91, -1, v91, vcc
    v_cndmask_b32 v92, -1, v92, s[68:69]
    s_mov_b64 exec, vcc
    buffer_load_dwordx2 v[100:101], v100, s[8:11], s18 offen offset:0
    s_mov_b64 exec, s[68:69]
    buffer_load_dwordx2 v[102:103], v102, s[8:11], s18 offen offset:768
    s_mov_b64 exec, -1
    v_ashrrev_i32 v71, 2, v87
    v_lshrrev_b32 v87, 4, v87
    v_and_b32 v87, 0x1fff8, v87
    v_ashrrev_i32 v84, 2, v88
    v_lshrrev_b32 v88, 4, v88
    v_and_b32 v88, 0x1fff8, v88
    s_waitcnt vmcnt(4)
    ds_read_b64 v[116:117], v87 offset:61968
    ds_read_b64 v[118:119], v88 offset:61968
    v_mfma_f32_4x4x4_16b_bf16 v[14:17], v[120:121], v[104:105], 0
    v_mfma_f32_4x4x4_16b_bf16 v[18:21], v[120:121], v[106:107], 0
    v_and_b32 v71, 0x9ff80000, v71
    v_and_b32 v84, 0x9ff80000, v84
    s_nop 1
    v_cvt_pk_f16_f32 v22, v14, v15
    v_cvt_pk_f16_f32 v23, v16, v17
    v_cvt_pk_f16_f32 v24, v18, v19
    v_cvt_pk_f16_f32 v25, v20, v21
    s_waitcnt lgkmcnt(1)
    v_pk_fma_f16 v22, v22, v71, v116 op_sel:[0,1,0] op_sel_hi:[1,1,1]
    v_pk_fma_f16 v23, v23, v71, v117 op_sel:[0,1,0] op_sel_hi:[1,1,1]
    ds_wrxchg_rtn_b64 v[76:77], v87, v[22:23] offset:61968
    s_waitcnt lgkmcnt(1)
    v_pk_fma_f16 v24, v24, v84, v118 op_sel:[0,1,0] op_sel_hi:[1,1,1]
    v_pk_fma_f16 v25, v25, v84, v119 op_sel:[0,1,0] op_sel_hi:[1,1,1]
    ds_wrxchg_rtn_b64 v[78:79], v88, v[24:25] offset:61968
    v_mov_b32_dpp v105, v8 row_newbcast:7 row_mask:0xf bank_mask:0xf
    v_mov_b32_dpp v107, v8 row_newbcast:8 row_mask:0xf bank_mask:0xf
    v_cmp_ge_u32 vcc, v105, v2
    v_cmp_ge_u32 s[68:69], v107, v2
    v_and_b32 v104, 0x7f, v93
    v_and_b32 v106, 0x7f, v94
    v_lshl_add_u32 v104, v104, 3, v3
    v_lshl_add_u32 v106, v106, 3, v3
    v_cndmask_b32 v93, -1, v93, vcc
    v_cndmask_b32 v94, -1, v94, s[68:69]
    s_mov_b64 exec, vcc
    buffer_load_dwordx2 v[104:105], v104, s[8:11], s18 offen offset:1536
    s_mov_b64 exec, s[68:69]
    buffer_load_dwordx2 v[106:107], v106, s[8:11], s18 offen offset:2304
    s_mov_b64 exec, -1
    v_cmp_ne_u64 vcc, v[72:73], v[80:81]
    s_cbranch_vccz L_p2_kernel_fxz0
    s_andn2_b64 exec, vcc, s[82:83]
    v_pk_add_f16 v28, v72, v80 neg_lo:[0,1] neg_hi:[0,1]
    v_pk_add_f16 v29, v73, v81 neg_lo:[0,1] neg_hi:[0,1]
    v_mov_b32 v30, v99
    s_and_b64 exec, vcc, s[82:83]
    s_cbranch_scc0 L_p2_kernel_fxz0_n
    v_pk_add_f16 v26, v72, v80 neg_lo:[0,1] neg_hi:[0,1]
    v_pk_add_f16 v27, v73, v81 neg_lo:[0,1] neg_hi:[0,1]
    ds_pk_add_f16 v99, v26 offset:61968
    ds_pk_add_f16 v99, v27 offset:61972
L_p2_kernel_fxz0_n:
    s_or_b64 s[82:83], s[82:83], vcc
    s_mov_b64 exec, -1
L_p2_kernel_fxz0:
    v_cmp_ne_u64 vcc, v[74:75], v[82:83]
    s_cbranch_vccz L_p2_kernel_fxz1
    s_andn2_b64 exec, vcc, s[82:83]
    v_pk_add_f16 v28, v74, v82 neg_lo:[0,1] neg_hi:[0,1]
    v_pk_add_f16 v29, v75, v83 neg_lo:[0,1] neg_hi:[0,1]
    v_mov_b32 v30, v86
    s_and_b64 exec, vcc, s[82:83]
    s_cbranch_scc0 L_p2_kernel_fxz1_n
    v_pk_add_f16 v26, v74, v82 neg_lo:[0,1] neg_hi:[0,1]
    v_pk_add_f16 v27, v75, v83 neg_lo:[0,1] neg_hi:[0,1]
    ds_pk_add_f16 v86, v26 offset:61968
    ds_pk_add_f16 v86, v27 offset:61972
L_p2_kernel_fxz1_n:
    s_or_b64 s[82:83], s[82:83], vcc
    s_mov_b64 exec, -1
L_p2_kernel_fxz1:
    s_setprio 2
    v_ashrrev_i32 v71, 2, v89
    v_lshrrev_b32 v89, 4, v89
    v_and_b32 v89, 0x1fff8, v89
    v_ashrrev_i32 v84, 2, v90
    v_lshrrev_b32 v90, 4, v90
    v_and_b32 v90, 0x1fff8, v90
    s_waitcnt vmcnt(4)
    ds_read_b64 v[80:81], v89 offset:61968
    ds_read_b64 v[82:83], v90 offset:61968
    v_mfma_f32_4x4x4_16b_bf16 v[14:17], v[120:121], v[108:109], 0
    v_mfma_f32_4x4x4_16b_bf16 v[18:21], v[120:121], v[110:111], 0
    v_and_b32 v71, 0x9ff80000, v71
    v_and_b32 v84, 0x9ff80000, v84
    s_nop 1
    v_cvt_pk_f16_f32 v22, v14, v15
    v_cvt_pk_f16_f32 v23, v16, v17
    v_cvt_pk_f16_f32 v24, v18, v19
    v_cvt_pk_f16_f32 v25, v20, v21
    s_waitcnt lgkmcnt(1)
    v_pk_fma_f16 v22, v22, v71, v80 op_sel:[0,1,0] op_sel_hi:[1,1,1]
    v_pk_fma_f16 v23, v23, v71, v81 op_sel:[0,1,0] op_sel_hi:[1,1,1]
    ds_wrxchg_rtn_b64 v[72:73], v89, v[22:23] offset:61968
    s_waitcnt lgkmcnt(1)
    v_pk_fma_f16 v24, v24, v84, v82 op_sel:[0,1,0] op_sel_hi:[1,1,1]
    v_pk_fma_f16 v25, v25, v84, v83 op_sel:[0,1,0] op_sel_hi:[1,1,1]
    ds_wrxchg_rtn_b64 v[74:75], v90, v[24:25] offset:61968
    v_mov_b32_dpp v109, v8 row_newbcast:9 row_mask:0xf bank_mask:0xf
    v_mov_b32_dpp v111, v8 row_newbcast:10 row_mask:0xf bank_mask:0xf
    v_cmp_ge_u32 vcc, v109, v2
    v_cmp_ge_u32 s[68:69], v111, v2
    v_and_b32 v108, 0x7f, v95
    v_and_b32 v110, 0x7f, v96
    v_lshl_add_u32 v108, v108, 3, v3
    v_lshl_add_u32 v110, v110, 3, v3
    v_cndmask_b32 v95, -1, v95, vcc
    v_cndmask_b32 v96, -1, v96, s[68:69]
    s_mov_b64 exec, vcc
    buffer_load_dwordx2 v[108:109], v108, s[8:11], s18 offen offset:3072
    s_mov_b64 exec, s[68:69]
    buffer_load_dwordx2 v[110:111], v110, s[8:11], s29 offen offset:0
    s_mov_b64 exec, -1
    v_cmp_ne_u64 vcc, v[76:77], v[116:117]
    s_cbranch_vccz L_p2_kernel_fxz2
    s_andn2_b64 exec, vcc, s[82:83]
    v_pk_add_f16 v28, v76, v116 neg_lo:[0,1] neg_hi:[0,1]
    v_pk_add_f16 v29, v77, v117 neg_lo:[0,1] neg_hi:[0,1]
    v_mov_b32 v30, v87
    s_and_b64 exec, vcc, s[82:83]
    s_cbranch_scc0 L_p2_kernel_fxz2_n
    v_pk_add_f16 v26, v76, v116 neg_lo:[0,1] neg_hi:[0,1]
    v_pk_add_f16 v27, v77, v117 neg_lo:[0,1] neg_hi:[0,1]
    ds_pk_add_f16 v87, v26 offset:61968
    ds_pk_add_f16 v87, v27 offset:61972
L_p2_kernel_fxz2_n:
    s_or_b64 s[82:83], s[82:83], vcc
    s_mov_b64 exec, -1
L_p2_kernel_fxz2:
    v_cmp_ne_u64 vcc, v[78:79], v[118:119]
    s_cbranch_vccz L_p2_kernel_fxz3
    s_andn2_b64 exec, vcc, s[82:83]
    v_pk_add_f16 v28, v78, v118 neg_lo:[0,1] neg_hi:[0,1]
    v_pk_add_f16 v29, v79, v119 neg_lo:[0,1] neg_hi:[0,1]
    v_mov_b32 v30, v88
    s_and_b64 exec, vcc, s[82:83]
    s_cbranch_scc0 L_p2_kernel_fxz3_n
    v_pk_add_f16 v26, v78, v118 neg_lo:[0,1] neg_hi:[0,1]
    v_pk_add_f16 v27, v79, v119 neg_lo:[0,1] neg_hi:[0,1]
    ds_pk_add_f16 v88, v26 offset:61968
    ds_pk_add_f16 v88, v27 offset:61972
L_p2_kernel_fxz3_n:
    s_or_b64 s[82:83], s[82:83], vcc
    s_mov_b64 exec, -1
L_p2_kernel_fxz3:
    v_ashrrev_i32 v71, 2, v91
    v_lshrrev_b32 v91, 4, v91
    v_and_b32 v91, 0x1fff8, v91
    v_ashrrev_i32 v84, 2, v92
    v_lshrrev_b32 v92, 4, v92
    v_and_b32 v92, 0x1fff8, v92
    s_waitcnt vmcnt(4)
    ds_read_b64 v[116:117], v91 offset:61968
    ds_read_b64 v[118:119], v92 offset:61968
    ds_read_b64 v[112:113], v30 offset:61968
    v_mfma_f32_4x4x4_16b_bf16 v[14:17], v[120:121], v[100:101], 0
    v_mfma_f32_4x4x4_16b_bf16 v[18:21], v[120:121], v[102:103], 0
    v_and_b32 v71, 0x9ff80000, v71
    v_and_b32 v84, 0x9ff80000, v84
    s_nop 1
    v_cvt_pk_f16_f32 v22, v14, v15
    v_cvt_pk_f16_f32 v23, v16, v17
    v_cvt_pk_f16_f32 v24, v18, v19
    v_cvt_pk_f16_f32 v25, v20, v21
    s_waitcnt lgkmcnt(2)
    v_pk_fma_f16 v22, v22, v71, v116 op_sel:[0,1,0] op_sel_hi:[1,1,1]
    v_pk_fma_f16 v23, v23, v71, v117 op_sel:[0,1,0] op_sel_hi:[1,1,1]
    ds_wrxchg_rtn_b64 v[76:77], v91, v[22:23] offset:61968
    s_waitcnt lgkmcnt(2)
    v_pk_fma_f16 v24, v24, v84, v118 op_sel:[0,1,0] op_sel_hi:[1,1,1]
    v_pk_fma_f16 v25, v25, v84, v119 op_sel:[0,1,0] op_sel_hi:[1,1,1]
    ds_wrxchg_rtn_b64 v[78:79], v92, v[24:25] offset:61968
    s_waitcnt lgkmcnt(2)
    v_pk_add_f16 v28, v28, v112
    v_pk_add_f16 v29, v29, v113
    v_mov_b32 v31, v30
    ds_wrxchg_rtn_b64 v[114:115], v30, v[28:29] offset:61968
    v_mov_b32 v30, 0x1fff8
    s_mov_b64 s[82:83], 0
    v_mov_b32_dpp v101, v8 row_newbcast:11 row_mask:0xf bank_mask:0xf
    v_mov_b32_dpp v103, v8 row_newbcast:12 row_mask:0xf bank_mask:0xf
    v_cmp_ge_u32 vcc, v101, v2
    v_cmp_ge_u32 s[68:69], v103, v2
    v_and_b32 v100, 0x7f, v97
    v_and_b32 v102, 0x7f, v98
    v_lshl_add_u32 v100, v100, 3, v3
    v_lshl_add_u32 v102, v102, 3, v3
    v_cndmask_b32 v97, -1, v97, vcc
    v_cndmask_b32 v98, -1, v98, s[68:69]
    s_mov_b64 exec, vcc
    buffer_load_dwordx2 v[100:101], v100, s[8:11], s29 offen offset:768
    s_mov_b64 exec, s[68:69]
    buffer_load_dwordx2 v[102:103], v102, s[8:11], s29 offen offset:1536
    s_mov_b64 exec, -1
    v_cmp_ne_u64 vcc, v[72:73], v[80:81]
    s_cbranch_vccz L_p2_kernel_fxz4
    s_andn2_b64 exec, vcc, s[82:83]
    v_pk_add_f16 v28, v72, v80 neg_lo:[0,1] neg_hi:[0,1]
    v_pk_add_f16 v29, v73, v81 neg_lo:[0,1] neg_hi:[0,1]
    v_mov_b32 v30, v89
    s_and_b64 exec, vcc, s[82:83]
    s_cbranch_scc0 L_p2_kernel_fxz4_n
    v_pk_add_f16 v26, v72, v80 neg_lo:[0,1] neg_hi:[0,1]
    v_pk_add_f16 v27, v73, v81 neg_lo:[0,1] neg_hi:[0,1]
    ds_pk_add_f16 v89, v26 offset:61968
    ds_pk_add_f16 v89, v27 offset:61972
L_p2_kernel_fxz4_n:
    s_or_b64 s[82:83], s[82:83], vcc
    s_mov_b64 exec, -1
L_p2_kernel_fxz4:
    v_cmp_ne_u64 vcc, v[74:75], v[82:83]
    s_cbranch_vccz L_p2_kernel_fxz5
    s_andn2_b64 exec, vcc, s[82:83]
    v_pk_add_f16 v28, v74, v82 neg_lo:[0,1] neg_hi:[0,1]
    v_pk_add_f16 v29, v75, v83 neg_lo:[0,1] neg_hi:[0,1]
    v_mov_b32 v30, v90
    s_and_b64 exec, vcc, s[82:83]
    s_cbranch_scc0 L_p2_kernel_fxz5_n
    v_pk_add_f16 v26, v74, v82 neg_lo:[0,1] neg_hi:[0,1]
    v_pk_add_f16 v27, v75, v83 neg_lo:[0,1] neg_hi:[0,1]
    ds_pk_add_f16 v90, v26 offset:61968
    ds_pk_add_f16 v90, v27 offset:61972
L_p2_kernel_fxz5_n:
    s_or_b64 s[82:83], s[82:83], vcc
    s_mov_b64 exec, -1
L_p2_kernel_fxz5:
    s_setprio 1
    v_ashrrev_i32 v71, 2, v93
    v_lshrrev_b32 v93, 4, v93
    v_and_b32 v93, 0x1fff8, v93
    v_ashrrev_i32 v84, 2, v94
    v_lshrrev_b32 v94, 4, v94
    v_and_b32 v94, 0x1fff8, v94
    s_waitcnt vmcnt(4)
    ds_read_b64 v[80:81], v93 offset:61968
    ds_read_b64 v[82:83], v94 offset:61968
    v_mfma_f32_4x4x4_16b_bf16 v[14:17], v[120:121], v[104:105], 0
    v_mfma_f32_4x4x4_16b_bf16 v[18:21], v[120:121], v[106:107], 0
    v_and_b32 v71, 0x9ff80000, v71
    v_and_b32 v84, 0x9ff80000, v84
    s_nop 1
    v_cvt_pk_f16_f32 v22, v14, v15
    v_cvt_pk_f16_f32 v23, v16, v17
    v_cvt_pk_f16_f32 v24, v18, v19
    v_cvt_pk_f16_f32 v25, v20, v21
    s_waitcnt lgkmcnt(1)
    v_pk_fma_f16 v22, v22, v71, v80 op_sel:[0,1,0] op_sel_hi:[1,1,1]
    v_pk_fma_f16 v23, v23, v71, v81 op_sel:[0,1,0] op_sel_hi:[1,1,1]
    ds_wrxchg_rtn_b64 v[72:73], v93, v[22:23] offset:61968
    s_waitcnt lgkmcnt(1)
    v_pk_fma_f16 v24, v24, v84, v82 op_sel:[0,1,0] op_sel_hi:[1,1,1]
    v_pk_fma_f16 v25, v25, v84, v83 op_sel:[0,1,0] op_sel_hi:[1,1,1]
    ds_wrxchg_rtn_b64 v[74:75], v94, v[24:25] offset:61968
    v_cmp_ne_u64 vcc, v[76:77], v[116:117]
    s_cbranch_vccz L_p2_kernel_fxz6
    s_andn2_b64 exec, vcc, s[82:83]
    v_pk_add_f16 v28, v76, v116 neg_lo:[0,1] neg_hi:[0,1]
    v_pk_add_f16 v29, v77, v117 neg_lo:[0,1] neg_hi:[0,1]
    v_mov_b32 v30, v91
    s_and_b64 exec, vcc, s[82:83]
    s_cbranch_scc0 L_p2_kernel_fxz6_n
    v_pk_add_f16 v26, v76, v116 neg_lo:[0,1] neg_hi:[0,1]
    v_pk_add_f16 v27, v77, v117 neg_lo:[0,1] neg_hi:[0,1]
    ds_pk_add_f16 v91, v26 offset:61968
    ds_pk_add_f16 v91, v27 offset:61972
L_p2_kernel_fxz6_n:
    s_or_b64 s[82:83], s[82:83], vcc
    s_mov_b64 exec, -1
L_p2_kernel_fxz6:
    v_cmp_ne_u64 vcc, v[78:79], v[118:119]
    s_cbranch_vccz L_p2_kernel_fxz7
    s_andn2_b64 exec, vcc, s[82:83]
    v_pk_add_f16 v28, v78, v118 neg_lo:[0,1] neg_hi:[0,1]
    v_pk_add_f16 v29, v79, v119 neg_lo:[0,1] neg_hi:[0,1]
    v_mov_b32 v30, v92
    s_and_b64 exec, vcc, s[82:83]
    s_cbranch_scc0 L_p2_kernel_fxz7_n
    v_pk_add_f16 v26, v78, v118 neg_lo:[0,1] neg_hi:[0,1]
    v_pk_add_f16 v27, v79, v119 neg_lo:[0,1] neg_hi:[0,1]
    ds_pk_add_f16 v92, v26 offset:61968
    ds_pk_add_f16 v92, v27 offset:61972
L_p2_kernel_fxz7_n:
    s_or_b64 s[82:83], s[82:83], vcc
    s_mov_b64 exec, -1
L_p2_kernel_fxz7:
    v_cmp_ne_u64 vcc, v[114:115], v[112:113]
    s_cbranch_vccz L_p2_kernel_flz8
    v_pk_add_f16 v26, v114, v112 neg_lo:[0,1] neg_hi:[0,1]
    v_pk_add_f16 v27, v115, v113 neg_lo:[0,1] neg_hi:[0,1]
    s_mov_b64 exec, vcc
    ds_pk_add_f16 v31, v26 offset:61968
    ds_pk_add_f16 v31, v27 offset:61972
    s_mov_b64 exec, -1
L_p2_kernel_flz8:
    v_ashrrev_i32 v71, 2, v95
    v_lshrrev_b32 v95, 4, v95
    v_and_b32 v95, 0x1fff8, v95
    v_ashrrev_i32 v84, 2, v96
    v_lshrrev_b32 v96, 4, v96
    v_and_b32 v96, 0x1fff8, v96
    s_waitcnt vmcnt(2)
    ds_read_b64 v[116:117], v95 offset:61968
    ds_read_b64 v[118:119], v96 offset:61968
    v_mfma_f32_4x4x4_16b_bf16 v[14:17], v[120:121], v[108:109], 0
    v_mfma_f32_4x4x4_16b_bf16 v[18:21], v[120:121], v[110:111], 0
    v_and_b32 v71, 0x9ff80000, v71
    v_and_b32 v84, 0x9ff80000, v84
    s_nop 1
    v_cvt_pk_f16_f32 v22, v14, v15
    v_cvt_pk_f16_f32 v23, v16, v17
    v_cvt_pk_f16_f32 v24, v18, v19
    v_cvt_pk_f16_f32 v25, v20, v21
    s_waitcnt lgkmcnt(1)
    v_pk_fma_f16 v22, v22, v71, v116 op_sel:[0,1,0] op_sel_hi:[1,1,1]
    v_pk_fma_f16 v23, v23, v71, v117 op_sel:[0,1,0] op_sel_hi:[1,1,1]
    ds_wrxchg_rtn_b64 v[76:77], v95, v[22:23] offset:61968
    s_waitcnt lgkmcnt(1)
    v_pk_fma_f16 v24, v24, v84, v118 op_sel:[0,1,0] op_sel_hi:[1,1,1]
    v_pk_fma_f16 v25, v25, v84, v119 op_sel:[0,1,0] op_sel_hi:[1,1,1]
    ds_wrxchg_rtn_b64 v[78:79], v96, v[24:25] offset:61968
    v_cmp_ne_u64 vcc, v[72:73], v[80:81]
    s_cbranch_vccz L_p2_kernel_fxz8
    s_andn2_b64 exec, vcc, s[82:83]
    v_pk_add_f16 v28, v72, v80 neg_lo:[0,1] neg_hi:[0,1]
    v_pk_add_f16 v29, v73, v81 neg_lo:[0,1] neg_hi:[0,1]
    v_mov_b32 v30, v93
    s_and_b64 exec, vcc, s[82:83]
    s_cbranch_scc0 L_p2_kernel_fxz8_n
    v_pk_add_f16 v26, v72, v80 neg_lo:[0,1] neg_hi:[0,1]
    v_pk_add_f16 v27, v73, v81 neg_lo:[0,1] neg_hi:[0,1]
    ds_pk_add_f16 v93, v26 offset:61968
    ds_pk_add_f16 v93, v27 offset:61972
L_p2_kernel_fxz8_n:
    s_or_b64 s[82:83], s[82:83], vcc
    s_mov_b64 exec, -1
L_p2_kernel_fxz8:
    v_cmp_ne_u64 vcc, v[74:75], v[82:83]
    s_cbranch_vccz L_p2_kernel_fxz9
    s_andn2_b64 exec, vcc, s[82:83]
    v_pk_add_f16 v28, v74, v82 neg_lo:[0,1] neg_hi:[0,1]
    v_pk_add_f16 v29, v75, v83 neg_lo:[0,1] neg_hi:[0,1]
    v_mov_b32 v30, v94
    s_and_b64 exec, vcc, s[82:83]
    s_cbranch_scc0 L_p2_kernel_fxz9_n
    v_pk_add_f16 v26, v74, v82 neg_lo:[0,1] neg_hi:[0,1]
    v_pk_add_f16 v27, v75, v83 neg_lo:[0,1] neg_hi:[0,1]
    ds_pk_add_f16 v94, v26 offset:61968
    ds_pk_add_f16 v94, v27 offset:61972
L_p2_kernel_fxz9_n:
    s_or_b64 s[82:83], s[82:83], vcc
    s_mov_b64 exec, -1
L_p2_kernel_fxz9:
    s_setprio 0
    v_ashrrev_i32 v71, 2, v97
    v_lshrrev_b32 v97, 4, v97
    v_and_b32 v97, 0x1fff8, v97
    v_ashrrev_i32 v84, 2, v98
    v_lshrrev_b32 v98, 4, v98
    v_and_b32 v98, 0x1fff8, v98
    s_waitcnt vmcnt(0)
    ds_read_b64 v[80:81], v97 offset:61968
    ds_read_b64 v[82:83], v98 offset:61968
    ds_read_b64 v[112:113], v30 offset:61968
    v_mfma_f32_4x4x4_16b_bf16 v[14:17], v[120:121], v[100:101], 0
    v_mfma_f32_4x4x4_16b_bf16 v[18:21], v[120:121], v[102:103], 0
    v_and_b32 v71, 0x9ff80000, v71
    v_and_b32 v84, 0x9ff80000, v84
    s_nop 1
    v_cvt_pk_f16_f32 v22, v14, v15
    v_cvt_pk_f16_f32 v23, v16, v17
    v_cvt_pk_f16_f32 v24, v18, v19
    v_cvt_pk_f16_f32 v25, v20, v21
    s_waitcnt lgkmcnt(2)
    v_pk_fma_f16 v22, v22, v71, v80 op_sel:[0,1,0] op_sel_hi:[1,1,1]
    v_pk_fma_f16 v23, v23, v71, v81 op_sel:[0,1,0] op_sel_hi:[1,1,1]
    ds_wrxchg_rtn_b64 v[72:73], v97, v[22:23] offset:61968
    s_waitcnt lgkmcnt(2)
    v_pk_fma_f16 v24, v24, v84, v82 op_sel:[0,1,0] op_sel_hi:[1,1,1]
    v_pk_fma_f16 v25, v25, v84, v83 op_sel:[0,1,0] op_sel_hi:[1,1,1]
    ds_wrxchg_rtn_b64 v[74:75], v98, v[24:25] offset:61968
    s_waitcnt lgkmcnt(2)
    v_pk_add_f16 v28, v28, v112
    v_pk_add_f16 v29, v29, v113
    v_mov_b32 v31, v30
    ds_wrxchg_rtn_b64 v[114:115], v30, v[28:29] offset:61968
    v_mov_b32 v30, 0x1fff8
    s_mov_b64 s[82:83], 0
    v_cmp_ne_u64 vcc, v[76:77], v[116:117]
    s_cbranch_vccz L_p2_kernel_fxz10
    v_pk_add_f16 v26, v76, v116 neg_lo:[0,1] neg_hi:[0,1]
    v_pk_add_f16 v27, v77, v117 neg_lo:[0,1] neg_hi:[0,1]
    s_mov_b64 exec, vcc
    ds_pk_add_f16 v95, v26 offset:61968
    ds_pk_add_f16 v95, v27 offset:61972
    s_mov_b64 exec, -1
L_p2_kernel_fxz10:
    v_cmp_ne_u64 vcc, v[78:79], v[118:119]
    s_cbranch_vccz L_p2_kernel_fxz11
    v_pk_add_f16 v26, v78, v118 neg_lo:[0,1] neg_hi:[0,1]
    v_pk_add_f16 v27, v79, v119 neg_lo:[0,1] neg_hi:[0,1]
    s_mov_b64 exec, vcc
    ds_pk_add_f16 v96, v26 offset:61968
    ds_pk_add_f16 v96, v27 offset:61972
    s_mov_b64 exec, -1
L_p2_kernel_fxz11:
    s_waitcnt lgkmcnt(2)
    v_cmp_ne_u64 vcc, v[72:73], v[80:81]
    s_cbranch_vccz L_p2_kernel_fxz12
    v_pk_add_f16 v26, v72, v80 neg_lo:[0,1] neg_hi:[0,1]
    v_pk_add_f16 v27, v73, v81 neg_lo:[0,1] neg_hi:[0,1]
    s_mov_b64 exec, vcc
    ds_pk_add_f16 v97, v26 offset:61968
    ds_pk_add_f16 v97, v27 offset:61972
    s_mov_b64 exec, -1
L_p2_kernel_fxz12:
    s_waitcnt lgkmcnt(1)
    v_cmp_ne_u64 vcc, v[74:75], v[82:83]
    s_cbranch_vccz L_p2_kernel_fxz13
    v_pk_add_f16 v26, v74, v82 neg_lo:[0,1] neg_hi:[0,1]
    v_pk_add_f16 v27, v75, v83 neg_lo:[0,1] neg_hi:[0,1]
    s_mov_b64 exec, vcc
    ds_pk_add_f16 v98, v26 offset:61968
    ds_pk_add_f16 v98, v27 offset:61972
    s_mov_b64 exec, -1
L_p2_kernel_fxz13:
    s_waitcnt lgkmcnt(0)
    v_cmp_ne_u64 vcc, v[114:115], v[112:113]
    s_cbranch_vccz L_p2_kernel_flz15
    v_pk_add_f16 v26, v114, v112 neg_lo:[0,1] neg_hi:[0,1]
    v_pk_add_f16 v27, v115, v113 neg_lo:[0,1] neg_hi:[0,1]
    s_mov_b64 exec, vcc
    ds_pk_add_f16 v31, v26 offset:61968
    ds_pk_add_f16 v31, v27 offset:61972
    s_mov_b64 exec, -1
L_p2_kernel_flz15:
    s_add_u32 s15, s15, 320000
    s_mov_b32 s60, 0
    s_mov_b32 s62, 1
    v_lshlrev_b32 v1, 4, v0
    s_waitcnt lgkmcnt(0)
    v_and_b32 v52, 3, v0
    v_mul_u32_u24 v52, 48, v52
    global_load_dwordx4 v[32:35], v52, s[88:89] offset:0
    global_load_dwordx4 v[36:39], v52, s[88:89] offset:16
    global_load_dwordx4 v[40:43], v52, s[88:89] offset:32
    s_mul_i32 s13, s63, 25088
    v_lshl_add_u32 v52, v0, 4, s13
    v_add_u32 v53, 16384, v52
    v_lshrrev_b32 v54, 2, v52
    v_lshrrev_b32 v55, 2, v53
    s_mov_b64 exec, -1
    buffer_load_dword v54, v54, s[36:39], 0 offen
    buffer_load_dwordx4 v[44:47], v52, s[44:47], 0 offen
    s_mov_b64 exec, s[66:67]
    buffer_load_dword v55, v55, s[36:39], 0 offen
    buffer_load_dwordx4 v[48:51], v53, s[44:47], 0 offen
    s_mov_b64 exec, -1
L_p2_kernel_e2:
    s_barrier
    s_add_u32 s13, s63, 1
    s_and_b32 s13, s13, 3
    s_mul_i32 s13, s13, 25088
    v_add_u32 v112, s13, v1
    v_add_u32 v113, 16384, v112
    s_add_u32 s13, s63, 2
    s_and_b32 s13, s13, 3
    s_mul_i32 s13, s13, 25088
    v_add_u32 v114, s13, v1
    v_add_u32 v115, 16384, v114
    s_add_u32 s13, s63, 3
    s_and_b32 s13, s13, 3
    s_mul_i32 s13, s13, 25088
    v_add_u32 v116, s13, v1
    v_add_u32 v117, 16384, v116
    s_mov_b64 exec, -1
    ds_read_b128 v[64:67], v112 offset:61968
    ds_read_b128 v[72:75], v114 offset:61968
    ds_read_b128 v[80:83], v116 offset:61968
    s_mov_b64 exec, s[66:67]
    ds_read_b128 v[68:71], v113 offset:61968
    ds_read_b128 v[76:79], v115 offset:61968
    ds_read_b128 v[84:87], v117 offset:61968
    s_mov_b64 exec, -1
    s_waitcnt lgkmcnt(5)
    buffer_store_dwordx4 v[64:67], v112, s[84:87], 0 offen sc1
    s_waitcnt lgkmcnt(4)
    buffer_store_dwordx4 v[72:75], v114, s[84:87], 0 offen sc1
    s_waitcnt lgkmcnt(3)
    buffer_store_dwordx4 v[80:83], v116, s[84:87], 0 offen sc1
    s_mov_b64 exec, s[66:67]
    s_waitcnt lgkmcnt(2)
    buffer_store_dwordx4 v[68:71], v113, s[84:87], 0 offen sc1
    s_waitcnt lgkmcnt(1)
    buffer_store_dwordx4 v[76:79], v115, s[84:87], 0 offen sc1
    s_waitcnt lgkmcnt(0)
    buffer_store_dwordx4 v[84:87], v117, s[84:87], 0 offen sc1
    s_mov_b64 exec, -1
    s_waitcnt vmcnt(6)
    v_sub_u32 v122, 0, v122
    v_lshlrev_b32 v96, 16, v36
    v_and_b32 v97, 0xffff0000, v36
    v_lshlrev_b32 v98, 16, v37
    v_and_b32 v99, 0xffff0000, v37
    v_lshlrev_b32 v100, 16, v38
    v_and_b32 v101, 0xffff0000, v38
    v_lshlrev_b32 v102, 16, v39
    v_and_b32 v103, 0xffff0000, v39
    v_ldexp_f32 v96, v96, v122
    v_ldexp_f32 v97, v97, v122
    v_ldexp_f32 v98, v98, v122
    v_ldexp_f32 v99, v99, v122
    v_ldexp_f32 v100, v100, v122
    v_ldexp_f32 v101, v101, v122
    v_ldexp_f32 v102, v102, v122
    v_ldexp_f32 v103, v103, v122
    v_cvt_pk_bf16_f32 v36, v96, v97
    v_cvt_pk_bf16_f32 v37, v98, v99
    v_cvt_pk_bf16_f32 v38, v100, v101
    v_cvt_pk_bf16_f32 v39, v102, v103
    v_and_b32 v96, 3, v0
    v_lshlrev_b32 v96, 4, v96
    v_mov_b32 v32, 0x3c00
    v_mov_b32 v33, 0
    v_lshlrev_b64 v[32:33], v96, v[32:33]
    s_branch L_p2_kernel_rg
L_p2_kernel_fin:
    s_mul_i32 s13, s61, 25088
    v_lshl_add_u32 v52, v0, 4, s13
    v_add_u32 v53, 16384, v52
    v_lshrrev_b32 v54, 2, v52
    v_lshrrev_b32 v55, 2, v53
    s_mov_b64 exec, -1
    buffer_load_dword v54, v54, s[36:39], 0 offen
    buffer_load_dwordx4 v[44:47], v52, s[44:47], 0 offen
    s_mov_b64 exec, s[66:67]
    buffer_load_dword v55, v55, s[36:39], 0 offen
    buffer_load_dwordx4 v[48:51], v53, s[44:47], 0 offen
    s_mov_b64 exec, -1
    s_waitcnt vmcnt(0)
L_p2_kernel_rg:
    v_lshlrev_b32 v6, 16, v54
    v_and_b32 v7, 0xffff0000, v54
    v_pk_add_f32 v[96:97], v[6:7], s[52:53] op_sel:[0,0] op_sel_hi:[0,1] neg_lo:[0,1] neg_hi:[0,1]
    v_pk_add_f32 v[98:99], v[6:7], s[54:55] op_sel:[0,0] op_sel_hi:[0,1] neg_lo:[0,1] neg_hi:[0,1]
    v_pk_add_f32 v[100:101], v[6:7], s[56:57] op_sel:[0,0] op_sel_hi:[0,1] neg_lo:[0,1] neg_hi:[0,1]
    v_pk_add_f32 v[102:103], v[6:7], s[58:59] op_sel:[0,0] op_sel_hi:[0,1] neg_lo:[0,1] neg_hi:[0,1]
    v_cvt_pk_bf16_f32 v104, v96, v97
    v_cvt_pk_bf16_f32 v105, v98, v99
    v_cvt_pk_bf16_f32 v106, v100, v101
    v_cvt_pk_bf16_f32 v107, v102, v103
    v_lshlrev_b32 v96, 16, v104
    v_and_b32 v97, 0xffff0000, v104
    v_lshlrev_b32 v98, 16, v105
    v_and_b32 v99, 0xffff0000, v105
    v_lshlrev_b32 v100, 16, v106
    v_and_b32 v101, 0xffff0000, v106
    v_lshlrev_b32 v102, 16, v107
    v_and_b32 v103, 0xffff0000, v107
    v_mul_f32 v96, v96, v96
    v_mul_f32 v97, v97, v97
    v_mul_f32 v98, v98, v98
    v_mul_f32 v99, v99, v99
    v_mul_f32 v100, v100, v100
    v_mul_f32 v101, v101, v101
    v_mul_f32 v102, v102, v102
    v_mul_f32 v103, v103, v103
    v_cvt_pk_bf16_f32 v104, v96, v97
    v_cvt_pk_bf16_f32 v105, v98, v99
    v_cvt_pk_bf16_f32 v106, v100, v101
    v_cvt_pk_bf16_f32 v107, v102, v103
    v_lshlrev_b32 v96, 16, v104
    v_and_b32 v97, 0xffff0000, v104
    v_lshlrev_b32 v98, 16, v105
    v_and_b32 v99, 0xffff0000, v105
    v_lshlrev_b32 v100, 16, v106
    v_and_b32 v101, 0xffff0000, v106
    v_lshlrev_b32 v102, 16, v107
    v_and_b32 v103, 0xffff0000, v107
    v_mul_f32 v96, 0xc1200000, v96
    v_mul_f32 v97, 0xc1200000, v97
    v_mul_f32 v98, 0xc1200000, v98
    v_mul_f32 v99, 0xc1200000, v99
    v_mul_f32 v100, 0xc1200000, v100
    v_mul_f32 v101, 0xc1200000, v101
    v_mul_f32 v102, 0xc1200000, v102
    v_mul_f32 v103, 0xc1200000, v103
    v_cvt_pk_bf16_f32 v104, v96, v97
    v_cvt_pk_bf16_f32 v105, v98, v99
    v_cvt_pk_bf16_f32 v106, v100, v101
    v_cvt_pk_bf16_f32 v107, v102, v103
    v_lshlrev_b32 v96, 16, v104
    v_and_b32 v97, 0xffff0000, v104
    v_lshlrev_b32 v98, 16, v105
    v_and_b32 v99, 0xffff0000, v105
    v_lshlrev_b32 v100, 16, v106
    v_and_b32 v101, 0xffff0000, v106
    v_lshlrev_b32 v102, 16, v107
    v_and_b32 v103, 0xffff0000, v107
    v_mul_f32 v96, 0x3fb8aa3b, v96
    v_mul_f32 v97, 0x3fb8aa3b, v97
    v_mul_f32 v98, 0x3fb8aa3b, v98
    v_mul_f32 v99, 0x3fb8aa3b, v99
    v_mul_f32 v100, 0x3fb8aa3b, v100
    v_mul_f32 v101, 0x3fb8aa3b, v101
    v_mul_f32 v102, 0x3fb8aa3b, v102
    v_mul_f32 v103, 0x3fb8aa3b, v103
    v_exp_f32 v96, v96
    v_exp_f32 v97, v97
    v_exp_f32 v98, v98
    v_exp_f32 v99, v99
    v_exp_f32 v100, v100
    v_exp_f32 v101, v101
    v_exp_f32 v102, v102
    v_exp_f32 v103, v103
    v_cvt_pk_bf16_f32 v104, v96, v97
    v_cvt_pk_bf16_f32 v105, v98, v99
    v_cvt_pk_bf16_f32 v106, v100, v101
    v_cvt_pk_bf16_f32 v107, v102, v103
    v_pk_add_f32 v[96:97], v[6:7], s[52:53] op_sel:[1,0] op_sel_hi:[1,1] neg_lo:[0,1] neg_hi:[0,1]
    v_pk_add_f32 v[98:99], v[6:7], s[54:55] op_sel:[1,0] op_sel_hi:[1,1] neg_lo:[0,1] neg_hi:[0,1]
    v_pk_add_f32 v[100:101], v[6:7], s[56:57] op_sel:[1,0] op_sel_hi:[1,1] neg_lo:[0,1] neg_hi:[0,1]
    v_pk_add_f32 v[102:103], v[6:7], s[58:59] op_sel:[1,0] op_sel_hi:[1,1] neg_lo:[0,1] neg_hi:[0,1]
    v_cvt_pk_bf16_f32 v108, v96, v97
    v_cvt_pk_bf16_f32 v109, v98, v99
    v_cvt_pk_bf16_f32 v110, v100, v101
    v_cvt_pk_bf16_f32 v111, v102, v103
    v_lshlrev_b32 v96, 16, v108
    v_and_b32 v97, 0xffff0000, v108
    v_lshlrev_b32 v98, 16, v109
    v_and_b32 v99, 0xffff0000, v109
    v_lshlrev_b32 v100, 16, v110
    v_and_b32 v101, 0xffff0000, v110
    v_lshlrev_b32 v102, 16, v111
    v_and_b32 v103, 0xffff0000, v111
    v_mul_f32 v96, v96, v96
    v_mul_f32 v97, v97, v97
    v_mul_f32 v98, v98, v98
    v_mul_f32 v99, v99, v99
    v_mul_f32 v100, v100, v100
    v_mul_f32 v101, v101, v101
    v_mul_f32 v102, v102, v102
    v_mul_f32 v103, v103, v103
    v_cvt_pk_bf16_f32 v108, v96, v97
    v_cvt_pk_bf16_f32 v109, v98, v99
    v_cvt_pk_bf16_f32 v110, v100, v101
    v_cvt_pk_bf16_f32 v111, v102, v103
    v_lshlrev_b32 v96, 16, v108
    v_and_b32 v97, 0xffff0000, v108
    v_lshlrev_b32 v98, 16, v109
    v_and_b32 v99, 0xffff0000, v109
    v_lshlrev_b32 v100, 16, v110
    v_and_b32 v101, 0xffff0000, v110
    v_lshlrev_b32 v102, 16, v111
    v_and_b32 v103, 0xffff0000, v111
    v_mul_f32 v96, 0xc1200000, v96
    v_mul_f32 v97, 0xc1200000, v97
    v_mul_f32 v98, 0xc1200000, v98
    v_mul_f32 v99, 0xc1200000, v99
    v_mul_f32 v100, 0xc1200000, v100
    v_mul_f32 v101, 0xc1200000, v101
    v_mul_f32 v102, 0xc1200000, v102
    v_mul_f32 v103, 0xc1200000, v103
    v_cvt_pk_bf16_f32 v108, v96, v97
    v_cvt_pk_bf16_f32 v109, v98, v99
    v_cvt_pk_bf16_f32 v110, v100, v101
    v_cvt_pk_bf16_f32 v111, v102, v103
    v_lshlrev_b32 v96, 16, v108
    v_and_b32 v97, 0xffff0000, v108
    v_lshlrev_b32 v98, 16, v109
    v_and_b32 v99, 0xffff0000, v109
    v_lshlrev_b32 v100, 16, v110
    v_and_b32 v101, 0xffff0000, v110
    v_lshlrev_b32 v102, 16, v111
    v_and_b32 v103, 0xffff0000, v111
    v_mul_f32 v96, 0x3fb8aa3b, v96
    v_mul_f32 v97, 0x3fb8aa3b, v97
    v_mul_f32 v98, 0x3fb8aa3b, v98
    v_mul_f32 v99, 0x3fb8aa3b, v99
    v_mul_f32 v100, 0x3fb8aa3b, v100
    v_mul_f32 v101, 0x3fb8aa3b, v101
    v_mul_f32 v102, 0x3fb8aa3b, v102
    v_mul_f32 v103, 0x3fb8aa3b, v103
    v_exp_f32 v96, v96
    v_exp_f32 v97, v97
    v_exp_f32 v98, v98
    v_exp_f32 v99, v99
    v_exp_f32 v100, v100
    v_exp_f32 v101, v101
    v_exp_f32 v102, v102
    v_exp_f32 v103, v103
    v_cvt_pk_bf16_f32 v108, v96, v97
    v_cvt_pk_bf16_f32 v109, v98, v99
    v_cvt_pk_bf16_f32 v110, v100, v101
    v_cvt_pk_bf16_f32 v111, v102, v103
    s_nop 1
    v_mfma_f32_4x4x4_16b_bf16 v[10:13], v[36:37], v[104:105], 0
    v_mfma_f32_4x4x4_16b_bf16 v[26:29], v[40:41], v[104:105], 0
    v_mfma_f32_4x4x4_16b_bf16 v[14:17], v[36:37], v[108:109], 0
    v_mfma_f32_4x4x4_16b_bf16 v[2:5], v[40:41], v[108:109], 0
    v_mfma_f32_4x4x4_16b_bf16 v[10:13], v[38:39], v[106:107], v[10:13]
    v_mfma_f32_4x4x4_16b_bf16 v[26:29], v[42:43], v[106:107], v[26:29]
    v_mfma_f32_4x4x4_16b_bf16 v[14:17], v[38:39], v[110:111], v[14:17]
    v_mfma_f32_4x4x4_16b_bf16 v[2:5], v[42:43], v[110:111], v[2:5]
    s_nop 4
    v_cvt_pk_bf16_f32 v96, v26, v27
    v_cvt_pk_bf16_f32 v97, v28, v29
    v_cvt_pk_bf16_f32 v98, v2, v3
    v_cvt_pk_bf16_f32 v99, v4, v5
    v_lshlrev_b32 v26, 16, v96
    v_and_b32 v27, 0xffff0000, v96
    v_lshlrev_b32 v28, 16, v97
    v_and_b32 v29, 0xffff0000, v97
    v_lshlrev_b32 v2, 16, v98
    v_and_b32 v3, 0xffff0000, v98
    v_lshlrev_b32 v4, 16, v99
    v_and_b32 v5, 0xffff0000, v99
    s_cmp_eq_u64 s[66:67], 0
    s_cbranch_scc1 L_p2_kernel_rg1
    v_lshlrev_b32 v6, 16, v55
    v_and_b32 v7, 0xffff0000, v55
    v_pk_add_f32 v[96:97], v[6:7], s[52:53] op_sel:[0,0] op_sel_hi:[0,1] neg_lo:[0,1] neg_hi:[0,1]
    v_pk_add_f32 v[98:99], v[6:7], s[54:55] op_sel:[0,0] op_sel_hi:[0,1] neg_lo:[0,1] neg_hi:[0,1]
    v_pk_add_f32 v[100:101], v[6:7], s[56:57] op_sel:[0,0] op_sel_hi:[0,1] neg_lo:[0,1] neg_hi:[0,1]
    v_pk_add_f32 v[102:103], v[6:7], s[58:59] op_sel:[0,0] op_sel_hi:[0,1] neg_lo:[0,1] neg_hi:[0,1]
    v_cvt_pk_bf16_f32 v104, v96, v97
    v_cvt_pk_bf16_f32 v105, v98, v99
    v_cvt_pk_bf16_f32 v106, v100, v101
    v_cvt_pk_bf16_f32 v107, v102, v103
    v_lshlrev_b32 v96, 16, v104
    v_and_b32 v97, 0xffff0000, v104
    v_lshlrev_b32 v98, 16, v105
    v_and_b32 v99, 0xffff0000, v105
    v_lshlrev_b32 v100, 16, v106
    v_and_b32 v101, 0xffff0000, v106
    v_lshlrev_b32 v102, 16, v107
    v_and_b32 v103, 0xffff0000, v107
    v_mul_f32 v96, v96, v96
    v_mul_f32 v97, v97, v97
    v_mul_f32 v98, v98, v98
    v_mul_f32 v99, v99, v99
    v_mul_f32 v100, v100, v100
    v_mul_f32 v101, v101, v101
    v_mul_f32 v102, v102, v102
    v_mul_f32 v103, v103, v103
    v_cvt_pk_bf16_f32 v104, v96, v97
    v_cvt_pk_bf16_f32 v105, v98, v99
    v_cvt_pk_bf16_f32 v106, v100, v101
    v_cvt_pk_bf16_f32 v107, v102, v103
    v_lshlrev_b32 v96, 16, v104
    v_and_b32 v97, 0xffff0000, v104
    v_lshlrev_b32 v98, 16, v105
    v_and_b32 v99, 0xffff0000, v105
    v_lshlrev_b32 v100, 16, v106
    v_and_b32 v101, 0xffff0000, v106
    v_lshlrev_b32 v102, 16, v107
    v_and_b32 v103, 0xffff0000, v107
    v_mul_f32 v96, 0xc1200000, v96
    v_mul_f32 v97, 0xc1200000, v97
    v_mul_f32 v98, 0xc1200000, v98
    v_mul_f32 v99, 0xc1200000, v99
    v_mul_f32 v100, 0xc1200000, v100
    v_mul_f32 v101, 0xc1200000, v101
    v_mul_f32 v102, 0xc1200000, v102
    v_mul_f32 v103, 0xc1200000, v103
    v_cvt_pk_bf16_f32 v104, v96, v97
    v_cvt_pk_bf16_f32 v105, v98, v99
    v_cvt_pk_bf16_f32 v106, v100, v101
    v_cvt_pk_bf16_f32 v107, v102, v103
    v_lshlrev_b32 v96, 16, v104
    v_and_b32 v97, 0xffff0000, v104
    v_lshlrev_b32 v98, 16, v105
    v_and_b32 v99, 0xffff0000, v105
    v_lshlrev_b32 v100, 16, v106
    v_and_b32 v101, 0xffff0000, v106
    v_lshlrev_b32 v102, 16, v107
    v_and_b32 v103, 0xffff0000, v107
    v_mul_f32 v96, 0x3fb8aa3b, v96
    v_mul_f32 v97, 0x3fb8aa3b, v97
    v_mul_f32 v98, 0x3fb8aa3b, v98
    v_mul_f32 v99, 0x3fb8aa3b, v99
    v_mul_f32 v100, 0x3fb8aa3b, v100
    v_mul_f32 v101, 0x3fb8aa3b, v101
    v_mul_f32 v102, 0x3fb8aa3b, v102
    v_mul_f32 v103, 0x3fb8aa3b, v103
    v_exp_f32 v96, v96
    v_exp_f32 v97, v97
    v_exp_f32 v98, v98
    v_exp_f32 v99, v99
    v_exp_f32 v100, v100
    v_exp_f32 v101, v101
    v_exp_f32 v102, v102
    v_exp_f32 v103, v103
    v_cvt_pk_bf16_f32 v104, v96, v97
    v_cvt_pk_bf16_f32 v105, v98, v99
    v_cvt_pk_bf16_f32 v106, v100, v101
    v_cvt_pk_bf16_f32 v107, v102, v103
    v_pk_add_f32 v[96:97], v[6:7], s[52:53] op_sel:[1,0] op_sel_hi:[1,1] neg_lo:[0,1] neg_hi:[0,1]
    v_pk_add_f32 v[98:99], v[6:7], s[54:55] op_sel:[1,0] op_sel_hi:[1,1] neg_lo:[0,1] neg_hi:[0,1]
    v_pk_add_f32 v[100:101], v[6:7], s[56:57] op_sel:[1,0] op_sel_hi:[1,1] neg_lo:[0,1] neg_hi:[0,1]
    v_pk_add_f32 v[102:103], v[6:7], s[58:59] op_sel:[1,0] op_sel_hi:[1,1] neg_lo:[0,1] neg_hi:[0,1]
    v_cvt_pk_bf16_f32 v108, v96, v97
    v_cvt_pk_bf16_f32 v109, v98, v99
    v_cvt_pk_bf16_f32 v110, v100, v101
    v_cvt_pk_bf16_f32 v111, v102, v103
    v_lshlrev_b32 v96, 16, v108
    v_and_b32 v97, 0xffff0000, v108
    v_lshlrev_b32 v98, 16, v109
    v_and_b32 v99, 0xffff0000, v109
    v_lshlrev_b32 v100, 16, v110
    v_and_b32 v101, 0xffff0000, v110
    v_lshlrev_b32 v102, 16, v111
    v_and_b32 v103, 0xffff0000, v111
    v_mul_f32 v96, v96, v96
    v_mul_f32 v97, v97, v97
    v_mul_f32 v98, v98, v98
    v_mul_f32 v99, v99, v99
    v_mul_f32 v100, v100, v100
    v_mul_f32 v101, v101, v101
    v_mul_f32 v102, v102, v102
    v_mul_f32 v103, v103, v103
    v_cvt_pk_bf16_f32 v108, v96, v97
    v_cvt_pk_bf16_f32 v109, v98, v99
    v_cvt_pk_bf16_f32 v110, v100, v101
    v_cvt_pk_bf16_f32 v111, v102, v103
    v_lshlrev_b32 v96, 16, v108
    v_and_b32 v97, 0xffff0000, v108
    v_lshlrev_b32 v98, 16, v109
    v_and_b32 v99, 0xffff0000, v109
    v_lshlrev_b32 v100, 16, v110
    v_and_b32 v101, 0xffff0000, v110
    v_lshlrev_b32 v102, 16, v111
    v_and_b32 v103, 0xffff0000, v111
    v_mul_f32 v96, 0xc1200000, v96
    v_mul_f32 v97, 0xc1200000, v97
    v_mul_f32 v98, 0xc1200000, v98
    v_mul_f32 v99, 0xc1200000, v99
    v_mul_f32 v100, 0xc1200000, v100
    v_mul_f32 v101, 0xc1200000, v101
    v_mul_f32 v102, 0xc1200000, v102
    v_mul_f32 v103, 0xc1200000, v103
    v_cvt_pk_bf16_f32 v108, v96, v97
    v_cvt_pk_bf16_f32 v109, v98, v99
    v_cvt_pk_bf16_f32 v110, v100, v101
    v_cvt_pk_bf16_f32 v111, v102, v103
    v_lshlrev_b32 v96, 16, v108
    v_and_b32 v97, 0xffff0000, v108
    v_lshlrev_b32 v98, 16, v109
    v_and_b32 v99, 0xffff0000, v109
    v_lshlrev_b32 v100, 16, v110
    v_and_b32 v101, 0xffff0000, v110
    v_lshlrev_b32 v102, 16, v111
    v_and_b32 v103, 0xffff0000, v111
    v_mul_f32 v96, 0x3fb8aa3b, v96
    v_mul_f32 v97, 0x3fb8aa3b, v97
    v_mul_f32 v98, 0x3fb8aa3b, v98
    v_mul_f32 v99, 0x3fb8aa3b, v99
    v_mul_f32 v100, 0x3fb8aa3b, v100
    v_mul_f32 v101, 0x3fb8aa3b, v101
    v_mul_f32 v102, 0x3fb8aa3b, v102
    v_mul_f32 v103, 0x3fb8aa3b, v103
    v_exp_f32 v96, v96
    v_exp_f32 v97, v97
    v_exp_f32 v98, v98
    v_exp_f32 v99, v99
    v_exp_f32 v100, v100
    v_exp_f32 v101, v101
    v_exp_f32 v102, v102
    v_exp_f32 v103, v103
    v_cvt_pk_bf16_f32 v108, v96, v97
    v_cvt_pk_bf16_f32 v109, v98, v99
    v_cvt_pk_bf16_f32 v110, v100, v101
    v_cvt_pk_bf16_f32 v111, v102, v103
    s_nop 1
    v_mfma_f32_4x4x4_16b_bf16 v[18:21], v[36:37], v[104:105], 0
    v_mfma_f32_4x4x4_16b_bf16 v[56:59], v[40:41], v[104:105], 0
    v_mfma_f32_4x4x4_16b_bf16 v[22:25], v[36:37], v[108:109], 0
    v_mfma_f32_4x4x4_16b_bf16 v[60:63], v[40:41], v[108:109], 0
    v_mfma_f32_4x4x4_16b_bf16 v[18:21], v[38:39], v[106:107], v[18:21]
    v_mfma_f32_4x4x4_16b_bf16 v[56:59], v[42:43], v[106:107], v[56:59]
    v_mfma_f32_4x4x4_16b_bf16 v[22:25], v[38:39], v[110:111], v[22:25]
    v_mfma_f32_4x4x4_16b_bf16 v[60:63], v[42:43], v[110:111], v[60:63]
    s_nop 4
    v_cvt_pk_bf16_f32 v96, v56, v57
    v_cvt_pk_bf16_f32 v97, v58, v59
    v_cvt_pk_bf16_f32 v98, v60, v61
    v_cvt_pk_bf16_f32 v99, v62, v63
    v_lshlrev_b32 v56, 16, v96
    v_and_b32 v57, 0xffff0000, v96
    v_lshlrev_b32 v58, 16, v97
    v_and_b32 v59, 0xffff0000, v97
    v_lshlrev_b32 v60, 16, v98
    v_and_b32 v61, 0xffff0000, v98
    v_lshlrev_b32 v62, 16, v99
    v_and_b32 v63, 0xffff0000, v99
L_p2_kernel_rg1:
    s_cmp_eq_u32 s62, 0
    s_cbranch_scc1 L_p2_kernel_na
    v_mov_b32 v118, 0
    v_mov_b32 v119, 1
    s_waitcnt vmcnt(0)
    s_mov_b64 exec, 1
    global_atomic_add v119, v118, v119, s[64:65] sc0 sc1
    s_mov_b64 exec, -1
L_p2_kernel_na:
    s_cmp_eq_u32 s62, 0
    s_cbranch_scc1 L_p2_kernel_go
    s_mov_b32 s62, 0
    s_waitcnt vmcnt(0)
    v_readfirstlane_b32 s13, v119
    s_lshr_b32 s60, s13, 8
    s_and_b32 s13, s13, 0xff
    s_cmp_eq_u32 s13, 3
    s_cbranch_scc1 L_p2_kernel_go
    s_mov_b32 s60, 0
    s_mov_b32 s17, 0
L_p2_kernel_poll:
    s_cmp_ge_u32 s17, 20000
    s_cbranch_scc1 L_p2_kernel_quit
    s_add_u32 s17, s17, 1
    s_mov_b64 exec, 1
    global_atomic_add v119, v118, v118, s[64:65] sc0 sc1
    s_mov_b64 exec, -1
    s_waitcnt vmcnt(0)
    v_readfirstlane_b32 s13, v119
    s_and_b32 s13, s13, 0xff
    s_cmp_eq_u32 s13, 4
    s_cbranch_scc1 L_p2_kernel_go
    s_sleep 10
    s_branch L_p2_kernel_poll
L_p2_kernel_quit:
    s_add_u32 s13, s63, 0
    s_and_b32 s13, s13, 3
    s_mul_i32 s13, s13, 25088
    v_add_u32 v112, s13, v1
    v_add_u32 v113, 16384, v112
    s_mov_b64 exec, -1
    ds_read_b128 v[64:67], v112 offset:61968
    s_mov_b64 exec, s[66:67]
    ds_read_b128 v[68:71], v113 offset:61968
    s_mov_b64 exec, -1
    s_waitcnt lgkmcnt(1)
    buffer_store_dwordx4 v[64:67], v112, s[84:87], 0 offen sc1
    s_mov_b64 exec, s[66:67]
    s_waitcnt lgkmcnt(0)
    buffer_store_dwordx4 v[68:71], v113, s[84:87], 0 offen sc1
    s_mov_b64 exec, -1
    s_lshl_b32 s13, 0x100, s63
    v_mov_b32 v119, s13
    s_waitcnt vmcnt(0)
    s_mov_b64 exec, 1
    global_atomic_add v119, v118, v119, s[64:65] sc0 sc1
    s_mov_b64 exec, -1
    s_waitcnt vmcnt(0)
    v_readfirstlane_b32 s13, v119
    s_and_b32 s13, s13, 0xff
    s_cmp_lg_u32 s13, 4
    s_cbranch_scc1 L_p2_kernel_end
L_p2_kernel_go:
    s_add_u32 s13, s63, 1
    s_and_b32 s13, s13, 3
    s_mul_i32 s73, s13, 6400000
    s_add_u32 s13, s63, 2
    s_and_b32 s13, s13, 3
    s_mul_i32 s74, s13, 6400000
    s_add_u32 s13, s63, 3
    s_and_b32 s13, s13, 3
    s_mul_i32 s75, s13, 6400000
    s_mov_b64 exec, -1
    buffer_load_dwordx4 v[68:71], v52, s[48:51], s73 offen sc1
    buffer_load_dwordx4 v[72:75], v52, s[48:51], s74 offen sc1
    buffer_load_dwordx4 v[76:79], v52, s[48:51], s75 offen sc1
    ds_read_b128 v[64:67], v52 offset:61968
    s_mov_b64 exec, s[66:67]
    buffer_load_dwordx4 v[84:87], v53, s[48:51], s73 offen sc1
    buffer_load_dwordx4 v[88:91], v53, s[48:51], s74 offen sc1
    buffer_load_dwordx4 v[92:95], v53, s[48:51], s75 offen sc1
    ds_read_b128 v[80:83], v53 offset:61968
    s_mov_b64 exec, -1
    v_lshlrev_b32 v112, 16, v44
    v_and_b32 v113, 0xffff0000, v44
    v_lshlrev_b32 v114, 16, v45
    v_and_b32 v115, 0xffff0000, v45
    v_lshlrev_b32 v116, 16, v46
    v_and_b32 v117, 0xffff0000, v46
    v_lshlrev_b32 v118, 16, v47
    v_and_b32 v119, 0xffff0000, v47
    s_waitcnt vmcnt(3) lgkmcnt(0)
    v_mfma_f32_4x4x4_16b_f16 v[96:99], v[32:33], v[64:65], 0
    v_mfma_f32_4x4x4_16b_f16 v[100:103], v[32:33], v[66:67], 0
    s_nop 0
    v_mfma_f32_4x4x4_16b_f16 v[96:99], v[32:33], v[68:69], v[96:99]
    v_mfma_f32_4x4x4_16b_f16 v[100:103], v[32:33], v[70:71], v[100:103]
    s_nop 0
    v_mfma_f32_4x4x4_16b_f16 v[96:99], v[32:33], v[72:73], v[96:99]
    v_mfma_f32_4x4x4_16b_f16 v[100:103], v[32:33], v[74:75], v[100:103]
    s_nop 0
    v_mfma_f32_4x4x4_16b_f16 v[96:99], v[32:33], v[76:77], v[96:99]
    v_mfma_f32_4x4x4_16b_f16 v[100:103], v[32:33], v[78:79], v[100:103]
    s_nop 4
    v_mul_f32 v96, v96, v10
    v_mul_f32 v97, v97, v11
    v_mul_f32 v98, v98, v12
    v_mul_f32 v99, v99, v13
    v_mul_f32 v100, v100, v14
    v_mul_f32 v101, v101, v15
    v_mul_f32 v102, v102, v16
    v_mul_f32 v103, v103, v17
    v_cvt_pk_bf16_f32 v120, v96, v97
    v_cvt_pk_bf16_f32 v121, v98, v99
    v_cvt_pk_bf16_f32 v122, v100, v101
    v_cvt_pk_bf16_f32 v123, v102, v103
    s_nop 1
    v_mfma_f32_4x4x4_16b_bf16 v[104:107], v[34:35], v[120:121], 0
    v_mfma_f32_4x4x4_16b_bf16 v[108:111], v[34:35], v[122:123], 0
    s_nop 4
    v_fmac_f32 v112, v104, v26
    v_fmac_f32 v113, v105, v27
    v_fmac_f32 v114, v106, v28
    v_fmac_f32 v115, v107, v29
    v_fmac_f32 v116, v108, v2
    v_fmac_f32 v117, v109, v3
    v_fmac_f32 v118, v110, v4
    v_fmac_f32 v119, v111, v5
    v_cvt_pk_bf16_f32 v44, v112, v113
    v_cvt_pk_bf16_f32 v45, v114, v115
    v_cvt_pk_bf16_f32 v46, v116, v117
    v_cvt_pk_bf16_f32 v47, v118, v119
    s_mov_b64 exec, -1
    buffer_store_dwordx4 v[44:47], v52, s[40:43], 0 offen sc1
    s_mov_b64 exec, -1
    s_cmp_eq_u64 s[66:67], 0
    s_cbranch_scc1 L_p2_kernel_f1
    v_lshlrev_b32 v112, 16, v48
    v_and_b32 v113, 0xffff0000, v48
    v_lshlrev_b32 v114, 16, v49
    v_and_b32 v115, 0xffff0000, v49
    v_lshlrev_b32 v116, 16, v50
    v_and_b32 v117, 0xffff0000, v50
    v_lshlrev_b32 v118, 16, v51
    v_and_b32 v119, 0xffff0000, v51
    s_waitcnt vmcnt(1) lgkmcnt(0)
    v_mfma_f32_4x4x4_16b_f16 v[96:99], v[32:33], v[80:81], 0
    v_mfma_f32_4x4x4_16b_f16 v[100:103], v[32:33], v[82:83], 0
    s_nop 0
    v_mfma_f32_4x4x4_16b_f16 v[96:99], v[32:33], v[84:85], v[96:99]
    v_mfma_f32_4x4x4_16b_f16 v[100:103], v[32:33], v[86:87], v[100:103]
    s_nop 0
    v_mfma_f32_4x4x4_16b_f16 v[96:99], v[32:33], v[88:89], v[96:99]
    v_mfma_f32_4x4x4_16b_f16 v[100:103], v[32:33], v[90:91], v[100:103]
    s_nop 0
    v_mfma_f32_4x4x4_16b_f16 v[96:99], v[32:33], v[92:93], v[96:99]
    v_mfma_f32_4x4x4_16b_f16 v[100:103], v[32:33], v[94:95], v[100:103]
    s_nop 4
    v_mul_f32 v96, v96, v18
    v_mul_f32 v97, v97, v19
    v_mul_f32 v98, v98, v20
    v_mul_f32 v99, v99, v21
    v_mul_f32 v100, v100, v22
    v_mul_f32 v101, v101, v23
    v_mul_f32 v102, v102, v24
    v_mul_f32 v103, v103, v25
    v_cvt_pk_bf16_f32 v120, v96, v97
    v_cvt_pk_bf16_f32 v121, v98, v99
    v_cvt_pk_bf16_f32 v122, v100, v101
    v_cvt_pk_bf16_f32 v123, v102, v103
    s_nop 1
    v_mfma_f32_4x4x4_16b_bf16 v[104:107], v[34:35], v[120:121], 0
    v_mfma_f32_4x4x4_16b_bf16 v[108:111], v[34:35], v[122:123], 0
    s_nop 4
    v_fmac_f32 v112, v104, v56
    v_fmac_f32 v113, v105, v57
    v_fmac_f32 v114, v106, v58
    v_fmac_f32 v115, v107, v59
    v_fmac_f32 v116, v108, v60
    v_fmac_f32 v117, v109, v61
    v_fmac_f32 v118, v110, v62
    v_fmac_f32 v119, v111, v63
    v_cvt_pk_bf16_f32 v48, v112, v113
    v_cvt_pk_bf16_f32 v49, v114, v115
    v_cvt_pk_bf16_f32 v50, v116, v117
    v_cvt_pk_bf16_f32 v51, v118, v119
    s_mov_b64 exec, s[66:67]
    buffer_store_dwordx4 v[48:51], v53, s[40:43], 0 offen sc1
    s_mov_b64 exec, -1
L_p2_kernel_f1:
    s_cmp_eq_u32 s60, 0
    s_cbranch_scc1 L_p2_kernel_fin_x
    s_ff1_i32_b32 s61, s60
    s_bitset0_b32 s60, s61
    s_waitcnt vmcnt(0)
    s_branch L_p2_kernel_fin
L_p2_kernel_fin_x:
L_p2_kernel_end:
    s_endpgm
L_p2_kernel_ovp0:
    v_cmp_le_u32 vcc, v65, v17
    s_cbranch_vccz L_p2_kernel_ovp0_0
    v_mov_b32 v84, v33
    v_mov_b32 v85, v14
    s_call_b64 s[20:21], L_p2_kernel_ovf
L_p2_kernel_ovp0_0:
    v_cmp_le_u32 vcc, v65, v18
    s_cbranch_vccz L_p2_kernel_ovp0_1
    v_mov_b32 v84, v34
    v_mov_b32 v85, v15
    s_call_b64 s[20:21], L_p2_kernel_ovf
L_p2_kernel_ovp0_1:
    v_cmp_le_u32 vcc, v65, v19
    s_cbranch_vccz L_p2_kernel_ovp0_2
    v_mov_b32 v84, v35
    v_mov_b32 v85, v16
    s_call_b64 s[20:21], L_p2_kernel_ovf
L_p2_kernel_ovp0_2:
    s_branch L_p2_kernel_ovp0_r
L_p2_kernel_ovp1:
    v_cmp_le_u32 vcc, v65, v23
    s_cbranch_vccz L_p2_kernel_ovp1_0
    v_mov_b32 v84, v37
    v_mov_b32 v85, v20
    s_call_b64 s[20:21], L_p2_kernel_ovf
L_p2_kernel_ovp1_0:
    v_cmp_le_u32 vcc, v65, v24
    s_cbranch_vccz L_p2_kernel_ovp1_1
    v_mov_b32 v84, v38
    v_mov_b32 v85, v21
    s_call_b64 s[20:21], L_p2_kernel_ovf
L_p2_kernel_ovp1_1:
    v_cmp_le_u32 vcc, v65, v25
    s_cbranch_vccz L_p2_kernel_ovp1_2
    v_mov_b32 v84, v39
    v_mov_b32 v85, v22
    s_call_b64 s[20:21], L_p2_kernel_ovf
L_p2_kernel_ovp1_2:
    s_branch L_p2_kernel_ovp1_r
L_p2_kernel_ovp2:
    v_cmp_le_u32 vcc, v65, v17
    s_cbranch_vccz L_p2_kernel_ovp2_0
    v_mov_b32 v84, v41
    v_mov_b32 v85, v14
    s_call_b64 s[20:21], L_p2_kernel_ovf
L_p2_kernel_ovp2_0:
    v_cmp_le_u32 vcc, v65, v18
    s_cbranch_vccz L_p2_kernel_ovp2_1
    v_mov_b32 v84, v42
    v_mov_b32 v85, v15
    s_call_b64 s[20:21], L_p2_kernel_ovf
L_p2_kernel_ovp2_1:
    v_cmp_le_u32 vcc, v65, v19
    s_cbranch_vccz L_p2_kernel_ovp2_2
    v_mov_b32 v84, v43
    v_mov_b32 v85, v16
    s_call_b64 s[20:21], L_p2_kernel_ovf
L_p2_kernel_ovp2_2:
    s_branch L_p2_kernel_ovp2_r
L_p2_kernel_ovp3:
    v_cmp_le_u32 vcc, v65, v23
    s_cbranch_vccz L_p2_kernel_ovp3_0
    v_mov_b32 v84, v45
    v_mov_b32 v85, v20
    s_call_b64 s[20:21], L_p2_kernel_ovf
L_p2_kernel_ovp3_0:
    v_cmp_le_u32 vcc, v65, v24
    s_cbranch_vccz L_p2_kernel_ovp3_1
    v_mov_b32 v84, v46
    v_mov_b32 v85, v21
    s_call_b64 s[20:21], L_p2_kernel_ovf
L_p2_kernel_ovp3_1:
    v_cmp_le_u32 vcc, v65, v25
    s_cbranch_vccz L_p2_kernel_ovp3_2
    v_mov_b32 v84, v47
    v_mov_b32 v85, v22
    s_call_b64 s[20:21], L_p2_kernel_ovf
L_p2_kernel_ovp3_2:
    s_branch L_p2_kernel_ovp3_r
L_p2_kernel_ovp4:
    v_cmp_le_u32 vcc, v65, v17
    s_cbranch_vccz L_p2_kernel_ovp4_0
    v_mov_b32 v84, v49
    v_mov_b32 v85, v14
    s_call_b64 s[20:21], L_p2_kernel_ovf
L_p2_kernel_ovp4_0:
    v_cmp_le_u32 vcc, v65, v18
    s_cbranch_vccz L_p2_kernel_ovp4_1
    v_mov_b32 v84, v50
    v_mov_b32 v85, v15
    s_call_b64 s[20:21], L_p2_kernel_ovf
L_p2_kernel_ovp4_1:
    v_cmp_le_u32 vcc, v65, v19
    s_cbranch_vccz L_p2_kernel_ovp4_2
    v_mov_b32 v84, v51
    v_mov_b32 v85, v16
    s_call_b64 s[20:21], L_p2_kernel_ovf
L_p2_kernel_ovp4_2:
    s_branch L_p2_kernel_ovp4_r
L_p2_kernel_ov0:
    v_cmp_le_u32 vcc, v65, v17
    s_cbranch_vccz L_p2_kernel_ov0_0
    v_mov_b32 v84, v33
    v_mov_b32 v85, v14
    s_call_b64 s[20:21], L_p2_kernel_ovf
L_p2_kernel_ov0_0:
    v_cmp_le_u32 vcc, v65, v18
    s_cbranch_vccz L_p2_kernel_ov0_1
    v_mov_b32 v84, v34
    v_mov_b32 v85, v15
    s_call_b64 s[20:21], L_p2_kernel_ovf
L_p2_kernel_ov0_1:
    v_cmp_le_u32 vcc, v65, v19
    s_cbranch_vccz L_p2_kernel_ov0_2
    v_mov_b32 v84, v35
    v_mov_b32 v85, v16
    s_call_b64 s[20:21], L_p2_kernel_ovf
L_p2_kernel_ov0_2:
    s_branch L_p2_kernel_ov0_r
L_p2_kernel_ov1:
    v_cmp_le_u32 vcc, v65, v23
    s_cbranch_vccz L_p2_kernel_ov1_0
    v_mov_b32 v84, v37
    v_mov_b32 v85, v20
    s_call_b64 s[20:21], L_p2_kernel_ovf
L_p2_kernel_ov1_0:
    v_cmp_le_u32 vcc, v65, v24
    s_cbranch_vccz L_p2_kernel_ov1_1
    v_mov_b32 v84, v38
    v_mov_b32 v85, v21
    s_call_b64 s[20:21], L_p2_kernel_ovf
L_p2_kernel_ov1_1:
    v_cmp_le_u32 vcc, v65, v25
    s_cbranch_vccz L_p2_kernel_ov1_2
    v_mov_b32 v84, v39
    v_mov_b32 v85, v22
    s_call_b64 s[20:21], L_p2_kernel_ovf
L_p2_kernel_ov1_2:
    s_branch L_p2_kernel_ov1_r
L_p2_kernel_ov2:
    v_cmp_le_u32 vcc, v65, v17
    s_cbranch_vccz L_p2_kernel_ov2_0
    v_mov_b32 v84, v41
    v_mov_b32 v85, v14
    s_call_b64 s[20:21], L_p2_kernel_ovf
L_p2_kernel_ov2_0:
    v_cmp_le_u32 vcc, v65, v18
    s_cbranch_vccz L_p2_kernel_ov2_1
    v_mov_b32 v84, v42
    v_mov_b32 v85, v15
    s_call_b64 s[20:21], L_p2_kernel_ovf
L_p2_kernel_ov2_1:
    v_cmp_le_u32 vcc, v65, v19
    s_cbranch_vccz L_p2_kernel_ov2_2
    v_mov_b32 v84, v43
    v_mov_b32 v85, v16
    s_call_b64 s[20:21], L_p2_kernel_ovf
L_p2_kernel_ov2_2:
    s_branch L_p2_kernel_ov2_r
L_p2_kernel_ov3:
    v_cmp_le_u32 vcc, v65, v23
    s_cbranch_vccz L_p2_kernel_ov3_0
    v_mov_b32 v84, v45
    v_mov_b32 v85, v20
    s_call_b64 s[20:21], L_p2_kernel_ovf
L_p2_kernel_ov3_0:
    v_cmp_le_u32 vcc, v65, v24
    s_cbranch_vccz L_p2_kernel_ov3_1
    v_mov_b32 v84, v46
    v_mov_b32 v85, v21
    s_call_b64 s[20:21], L_p2_kernel_ovf
L_p2_kernel_ov3_1:
    v_cmp_le_u32 vcc, v65, v25
    s_cbranch_vccz L_p2_kernel_ov3_2
    v_mov_b32 v84, v47
    v_mov_b32 v85, v22
    s_call_b64 s[20:21], L_p2_kernel_ovf
L_p2_kernel_ov3_2:
    s_branch L_p2_kernel_ov3_r
L_p2_kernel_ov4:
    v_cmp_le_u32 vcc, v65, v17
    s_cbranch_vccz L_p2_kernel_ov4_0
    v_mov_b32 v84, v49
    v_mov_b32 v85, v14
    s_call_b64 s[20:21], L_p2_kernel_ovf
L_p2_kernel_ov4_0:
    v_cmp_le_u32 vcc, v65, v18
    s_cbranch_vccz L_p2_kernel_ov4_1
    v_mov_b32 v84, v50
    v_mov_b32 v85, v15
    s_call_b64 s[20:21], L_p2_kernel_ovf
L_p2_kernel_ov4_1:
    v_cmp_le_u32 vcc, v65, v19
    s_cbranch_vccz L_p2_kernel_ov4_2
    v_mov_b32 v84, v51
    v_mov_b32 v85, v16
    s_call_b64 s[20:21], L_p2_kernel_ovf
L_p2_kernel_ov4_2:
    s_branch L_p2_kernel_ov4_r
L_p2_kernel_six:
    s_cmp_le_u32 s13, 32
    s_cbranch_scc1 L_p2_kernel_six_a
    s_mov_b64 vcc, 0
    s_mov_b32 s97, 8
    s_setpc_b64 s[20:21]
L_p2_kernel_six_a:
    s_mov_b64 s[26:27], vcc
    v_cmp_le_u32 vcc, 256, v126
    v_add_u32 v60, 4294967040, v126
    s_and_b64 vcc, vcc, s[26:27]
    s_andn2_b64 s[26:27], s[26:27], vcc
    v_cndmask_b32 v60, 4, v60, vcc
    ds_permute_b32 v61, v60, v52
    s_waitcnt lgkmcnt(0)
    v_add_u32_dpp v62, v61, v57 quad_perm:[0,0,0,0] row_mask:0xf bank_mask:0xf
    v_mov_b32 v60, 0
    v_cmp_le_i32 vcc, 0, v62
    v_and_b32 v62, 0x87ffffff, v62
    s_mov_b64 exec, vcc
    buffer_load_dwordx4 v[60:63], v62, s[4:7], 0 offen
    s_mov_b64 exec, -1
    s_mov_b32 s100, 1
    s_mov_b64 vcc, s[26:27]
    s_setpc_b64 s[20:21]
L_p2_kernel_bin5:
    s_mov_b32 s100, 0
    s_waitcnt vmcnt(0)
    v_lshrrev_b32 v15, 10, v60
    v_lshrrev_b32 v16, 20, v60
    v_bitop3_b32 v14, v60, s28, v66 bitop3:0x6a
    v_bitop3_b32 v15, v15, s28, v66 bitop3:0x6a
    v_bitop3_b32 v16, v16, s28, v66 bitop3:0x6a
    ds_add_rtn_u32 v17, v14, v6 offset:2052
    ds_add_rtn_u32 v18, v15, v6 offset:2052
    ds_add_rtn_u32 v19, v16, v6 offset:2052
    s_waitcnt lgkmcnt(0)
    v_min_u32 v20, v65, v17
    v_cmp_le_u32 vcc, v65, v17
    v_mad_u32_u24 v20, v14, 33, v20
    ds_write_b32 v20, v61
    s_cbranch_vccz L_p2_kernel_bin5_0
    v_mov_b32 v84, v61
    v_mov_b32 v85, v14
    s_call_b64 s[20:21], L_p2_kernel_ovf
L_p2_kernel_bin5_0:
    v_min_u32 v20, v65, v18
    v_cmp_le_u32 vcc, v65, v18
    v_mad_u32_u24 v20, v15, 33, v20
    ds_write_b32 v20, v62
    s_cbranch_vccz L_p2_kernel_bin5_1
    v_mov_b32 v84, v62
    v_mov_b32 v85, v15
    s_call_b64 s[20:21], L_p2_kernel_ovf
L_p2_kernel_bin5_1:
    v_min_u32 v20, v65, v19
    v_cmp_le_u32 vcc, v65, v19
    v_mad_u32_u24 v20, v16, 33, v20
    ds_write_b32 v20, v63
    s_cbranch_vccz L_p2_kernel_bin5_2
    v_mov_b32 v84, v63
    v_mov_b32 v85, v16
    s_call_b64 s[20:21], L_p2_kernel_ovf
L_p2_kernel_bin5_2:
    s_setpc_b64 s[24:25]
L_p2_kernel_long:
    s_ff1_i32_b64 s13, s[30:31]
    s_bitset0_b64 s[30:31], s13
    v_readlane_b32 s32, v13, s13
    s_lshr_b32 s33, s13, 1
    s_lshl_b32 s13, s14, 5
    s_add_u32 s33, s33, s13
    s_mul_i32 s33, s33, 151680
    s_and_b32 s13, s32, 0xffff
    s_lshl_b32 s13, s13, 4
    s_add_u32 s33, s33, s13
    s_lshl_b32 s13, s97, 4
    s_add_u32 s33, s33, s13
    s_sub_u32 s33, s33, 16
    s_lshr_b32 s32, s32, 16
    s_sub_u32 s32, s32, s97
L_p2_kernel_long_b:
    s_lshl_b32 s13, s32, 2
    v_sub_u32 v116, s13, v5
    v_ashrrev_i32 v116, 31, v116
    v_lshl_or_b32 v116, v5, 2, v116
    buffer_load_dwordx4 v[116:119], v116, s[4:7], s33 offen
    s_waitcnt vmcnt(0)
    v_lshrrev_b32 v85, 0, v116
    v_bitop3_b32 v85, v85, s28, v66 bitop3:0x6a
    v_sub_u32 v85, 161784, v85
    v_cmp_le_i32 vcc, 0, v85
    v_mov_b32 v84, v117
    s_mov_b64 exec, vcc
    s_call_b64 s[20:21], L_p2_kernel_dir
    v_lshrrev_b32 v85, 10, v116
    v_bitop3_b32 v85, v85, s28, v66 bitop3:0x6a
    v_sub_u32 v85, 161784, v85
    v_cmp_le_i32 vcc, 0, v85
    v_mov_b32 v84, v118
    s_mov_b64 exec, vcc
    s_call_b64 s[20:21], L_p2_kernel_dir
    v_lshrrev_b32 v85, 20, v116
    v_bitop3_b32 v85, v85, s28, v66 bitop3:0x6a
    v_sub_u32 v85, 161784, v85
    v_cmp_le_i32 vcc, 0, v85
    v_mov_b32 v84, v119
    s_mov_b64 exec, vcc
    s_call_b64 s[20:21], L_p2_kernel_dir
    s_cmp_gt_u32 s32, 64
    s_cbranch_scc0 L_p2_kernel_long_d
    s_sub_u32 s32, s32, 64
    s_add_u32 s33, s33, 1024
    s_branch L_p2_kernel_long_b
L_p2_kernel_long_d:
    s_cmp_lg_u64 s[30:31], 0
    s_cbranch_scc1 L_p2_kernel_long
    s_setpc_b64 s[24:25]
L_p2_kernel_ovf:
    s_mov_b64 exec, vcc
    v_mov_b32 v72, s12
    v_mbcnt_lo_u32_b32 v72, vcc_lo, v72
    v_mbcnt_hi_u32_b32 v72, vcc_hi, v72
    s_bcnt1_i32_b64 s13, vcc
    s_add_u32 s12, s12, s13
    v_cmp_gt_u32 vcc, 54, v72
    v_add_lshl_u32 v72, v72, s23, 3
    s_and_saveexec_b64 s[26:27], vcc
    ds_write_b64 v72, v[84:85]
    s_andn2_b64 exec, s[26:27], exec
    v_sub_u32 v85, 161784, v85
L_p2_kernel_dir:
    s_cbranch_execz L_p2_kernel_dir_x
    v_mov_b32 v73, 162160
L_p2_kernel_dir_w:
    ds_read_b32 v72, v73 offset:8
    s_waitcnt lgkmcnt(0)
    v_readfirstlane_b32 s13, v72
    s_cmp_lt_u32 s13, 64
    s_cbranch_scc1 L_p2_kernel_dir_w
    v_and_b32 v72, 0x7f, v84
    v_mul_u32_u24 v85, 192, v85
    v_lshl_add_u32 v72, v72, 3, v85
    buffer_load_dwordx2 v[72:73], v72, s[8:11], s16 offen
    v_ashrrev_i32 v85, 2, v84
    v_lshrrev_b32 v84, 4, v84
    v_and_b32 v85, 0x9ff80000, v85
    v_and_b32 v84, 0x1fff8, v84
    s_waitcnt vmcnt(0)
    v_mfma_f32_4x4x4_16b_bf16 v[74:77], v[120:121], v[72:73], 0
    s_nop 4
    v_fma_mixlo_f16 v72, v74, v85, 0 op_sel:[0,1,0] op_sel_hi:[0,1,0]
    v_fma_mixlo_f16 v73, v76, v85, 0 op_sel:[0,1,0] op_sel_hi:[0,1,0]
    v_fma_mixhi_f16 v72, v75, v85, 0 op_sel:[0,1,0] op_sel_hi:[0,1,0]
    v_fma_mixhi_f16 v73, v77, v85, 0 op_sel:[0,1,0] op_sel_hi:[0,1,0]
    s_nop 0
    ds_pk_add_f16 v84, v72 offset:61968
    ds_pk_add_f16 v84, v73 offset:61972
L_p2_kernel_dir_x:
    s_mov_b64 exec, -1
    s_setpc_b64 s[20:21]
L_code_end:
.section .rodata,"a"
.p2align 6
.amdhsa_kernel p1_kernel
  .amdhsa_next_free_vgpr 128
  .amdhsa_next_free_sgpr 102
  .amdhsa_accum_offset 128
  .amdhsa_group_segment_fixed_size 0
  .amdhsa_kernarg_size 112
  .amdhsa_user_sgpr_count 2
  .amdhsa_user_sgpr_kernarg_segment_ptr 1
  .amdhsa_system_sgpr_workgroup_id_x 1
  .amdhsa_float_denorm_mode_32 3
.end_amdhsa_kernel
.p2align 6
.amdhsa_kernel p2_kernel
  .amdhsa_next_free_vgpr 128
  .amdhsa_next_free_sgpr 102
  .amdhsa_accum_offset 128
  .amdhsa_group_segment_fixed_size 0
  .amdhsa_kernarg_size 112
  .amdhsa_user_sgpr_count 2
  .amdhsa_user_sgpr_kernarg_segment_ptr 1
  .amdhsa_system_sgpr_workgroup_id_x 1
  .amdhsa_float_denorm_mode_32 3
.end_amdhsa_kernel
```
